```python
import torch

def _softmax(x, axis=-1):
    return torch.softmax(x, dim=axis)
def _gelu(x):
    return torch.nn.functional.gelu(x, approximate="tanh")
def _silu(x):
    return torch.nn.functional.silu(x)
def _sigmoid(x):
    return torch.sigmoid(x)
def _layernorm(x, axis=-1, eps=1e-5):
    m = x.mean(dim=axis, keepdim=True)
    v = x.var(dim=axis, keepdim=True, unbiased=False)
    return (x - m) / torch.sqrt(v + eps)
def _scatter_add(tgt, idx, src, axis=0):
    return tgt.clone().index_add_(axis, idx, src)
def _segment_sum(src, seg, n):
    out = torch.zeros((n,) + src.shape[1:], dtype=src.dtype)
    return out.index_add_(0, seg, src)
def _pad(x, pw):
    flat = tuple(v for pair in reversed(pw) for v in pair)
    return torch.nn.functional.pad(x, flat)

kernel_name = 'sequential_preLN__mha_block_cached__swiglu_ffn__decode'

def setup_inputs():

    _w = (lambda a: (lambda t: t.to(torch.bfloat16) if t.is_floating_point() else t)(torch.as_tensor(a)))
    def _A_setup():
        B, Sq, D = 8, 1, 640
        H, Sk, Dh = 32, 4096, 128
        return {
            "x": _w((lambda *s: torch.randn(*s, dtype=torch.bfloat16) * 0.05)(B, Sq, D)),
            "k_cache": _w((lambda *s: torch.randn(*s, dtype=torch.bfloat16) * 3.2)(B, H, Sk, Dh)),
            "v_cache": _w((lambda *s: torch.randn(*s, dtype=torch.bfloat16) * 0.4)(B, H, Sk, Dh)),
            "wq": _w((lambda *s: torch.randn(*s, dtype=torch.bfloat16) * 3.2)(D, H * Dh) * (D ** -0.5)),
            "wo": _w((lambda *s: torch.randn(*s, dtype=torch.bfloat16) * 0.4)(H * Dh, D) * ((H * Dh) ** -0.5)),
        }
    _A_in = _A_setup()

    def _B_setup():
        B, S, D, F = 8, 1, 640, 1728
        return {
            "x": _w((lambda *s: torch.randn(*s, dtype=torch.bfloat16) * 0.05)(B, S, D)),
            "w_gate": _w((lambda *s: torch.randn(*s, dtype=torch.bfloat16) * 0.05)(D, F)),
            "w_up": _w((lambda *s: torch.randn(*s, dtype=torch.bfloat16) * 0.05)(D, F)),
            "w_down": _w((lambda *s: torch.randn(*s, dtype=torch.bfloat16) * 0.05)(F, D)),
        }
    _B_in = _B_setup()

    return {
        "A_x": _A_in["x"],
        "A_k_cache": _A_in["k_cache"],
        "A_v_cache": _A_in["v_cache"],
        "A_wq": _A_in["wq"],
        "A_wo": _A_in["wo"],
        "B_x": _B_in["x"],
        "B_w_gate": _B_in["w_gate"],
        "B_w_up": _B_in["w_up"],
        "B_w_down": _B_in["w_down"],
    }

def reference(A_x, A_k_cache, A_v_cache, A_wq, A_wo, B_x, B_w_gate, B_w_up, B_w_down):
    def _A_ref(x, k_cache, v_cache, wq, wo):
        B, Sq, D = x.shape
        H, Dh = 32, 128
        q = (lambda x, *d: x.permute(*d))((x @ wq).reshape(B, Sq, H, Dh), 0, 2, 1, 3)
        scores = torch.einsum("bhqd,bhkd->bhqk", q, k_cache) * (Dh ** -0.5)
        p = _softmax(scores, axis=-1)
        o = torch.einsum("bhqk,bhkd->bhqd", p, v_cache)
        return (lambda x, *d: x.permute(*d))(o, 0, 2, 1, 3).reshape(B, Sq, H * Dh) @ wo

    def _B_ref(x, w_gate, w_up, w_down):
        g = _silu(x @ w_gate)
        u = x @ w_up
        return (g * u) @ w_down

    x = A_x
    h = x + _A_ref(_layernorm(x, axis=-1), A_k_cache, A_v_cache, A_wq, A_wo)
    h2 = h + _B_ref(_layernorm(h, axis=-1), B_w_gate, B_w_up, B_w_down)
    return h2
```

```asm
; @launch grid=(256,1,1) block=(512,1,1) lds=157696
.amdgcn_target "amdgcn-amd-amdhsa--gfx950"
.text
.globl sequential_preLN__mha_block_cached__swiglu_ffn__decode_kernel
.p2align 8
.type sequential_preLN__mha_block_cached__swiglu_ffn__decode_kernel,@function
sequential_preLN__mha_block_cached__swiglu_ffn__decode_kernel:
    s_cmp_ge_u32 s2, 256
    s_cbranch_scc1 L_end
    s_load_dwordx16 s[64:79], s[0:1], 0
    s_load_dwordx8 s[80:87], s[0:1], 64
    s_setprio 3
    v_lshrrev_b32 v7, 6, v0
    v_and_b32 v28, 63, v0
    v_readfirstlane_b32 s40, v7
    v_lshlrev_b32 v1, 4, v28
    s_bfe_u32 s42, s2, 0x30000
    s_lshl_b32 s42, s42, 1
    s_bfe_u32 s45, s2, 0x10003
    s_or_b32 s42, s42, s45
    s_bfe_u32 s45, s2, 0x10004
    s_lshl_b32 s45, s45, 4
    s_or_b32 s42, s42, s45
    s_lshr_b32 s41, s2, 5
    s_lshl_b32 s3, s41, 5
    s_add_u32 s3, s3, s42
    s_bfm_b32 s36, s42, 0
    s_andn2_b32 s36, s36, 0xc000c400
    s_bcnt1_i32_b32 s36, s36
    s_bitcmp1_b32 0xc000c400, s42
    s_cselect_b32 s36, 31, s36
    s_lshl_b32 s37, s41, 5
    s_add_u32 s37, s37, s36
    s_lshl_b32 s46, s3, 20
    s_mov_b32 s6, 0x100000
    s_mov_b32 s7, 0x20000
    s_mov_b32 s10, s6
    s_mov_b32 s11, 0x20000
    s_movk_i32 s18, 1280
    s_mov_b32 s19, 0x20000
    s_mul_i32 s47, s41, 1280
    s_mul_i32 s43, s40, 4096
    v_lshrrev_b32 v29, 4, v28
    v_and_b32 v30, 15, v28
    v_lshlrev_b32 v31, 2, v28
    v_lshl_add_u32 v7, v30, 2, v29
    s_mul_i32 s48, s40, 80
    v_add_lshl_u32 v7, v7, s48, 1
    v_lshlrev_b32 v32, 13, v29
    v_lshl_add_u32 v32, v30, 4, v32
    s_waitcnt lgkmcnt(0)
    s_add_u32 s4, s66, s46
    s_addc_u32 s5, s67, 0
    s_add_u32 s16, s64, s47
    s_addc_u32 s17, s65, 0
    s_add_u32 s8, s68, s46
    s_addc_u32 s9, s69, 0
    buffer_load_dword v8, v31, s[16:19], 0 offen offset:0
    buffer_load_dword v9, v31, s[16:19], 0 offen offset:256
    buffer_load_dword v10, v31, s[16:19], 0 offen offset:512
    buffer_load_dword v11, v31, s[16:19], 0 offen offset:768
    buffer_load_dword v12, v31, s[16:19], 0 offen offset:1024
    buffer_load_ushort v13, v7, s[16:19], 0 offen
    buffer_load_ushort v14, v7, s[16:19], 0 offen offset:128
    buffer_load_dwordx4 v[40:43], v1, s[4:7], s43 offen offset:0 sc0 sc1 nt
    buffer_load_dwordx4 v[44:47], v1, s[4:7], s43 offen offset:1024 sc0 sc1 nt
    buffer_load_dwordx4 v[48:51], v1, s[4:7], s43 offen offset:2048 sc0 sc1 nt
    buffer_load_dwordx4 v[52:55], v1, s[4:7], s43 offen offset:3072 sc0 sc1 nt
    s_cmp_lg_u32 s40, 0
    s_cbranch_scc1 L_noreset2
    s_mov_b32 s28, s86
    s_mov_b32 s29, s87
    s_mov_b32 s30, 0x300000
    s_mov_b32 s31, 0x20000
    v_mov_b32 v20, -1
    v_mov_b32 v21, -1
    v_mov_b32 v22, -1
    v_mov_b32 v23, -1
    v_mov_b32 v25, 0
    s_mul_i32 s60, s37, 2560
    s_add_u32 s60, s60, 0x200000
    v_lshrrev_b32 v24, 1, v1
    buffer_store_dwordx4 v[20:23], v1, s[28:31], s60 offen sc1
    buffer_store_dwordx4 v[20:23], v1, s[28:31], s60 offen offset:1024 sc1
    buffer_store_dwordx2 v[20:21], v24, s[28:31], s60 offen offset:2048 sc1
    s_cmp_ge_u32 s42, 11
    s_cbranch_scc1 L_noreset
    s_lshl_b32 s59, s41, 12
    s_lshl_b32 s60, s42, 8
    s_add_u32 s59, s59, s60
    s_add_u32 s59, s59, 0x100000
    buffer_store_dword v25, v31, s[28:31], s59 offen sc1
L_noreset:
    s_waitcnt vmcnt(0)
    s_bfe_u32 s59, s2, 0x20003
    s_lshl_b32 s59, s59, 6
    v_mov_b32 v24, s59
    v_mov_b32 v25, 1
    s_mov_b64 exec, 1
    global_atomic_add v24, v25, s[84:85] sc1
    s_mov_b64 exec, -1
L_noreset2:
    s_mov_b32 s12, s70
    s_mov_b32 s13, s71
    s_mov_b32 s14, 5242880
    s_mov_b32 s15, 0x20000
    s_lshl_b32 s48, s48, 13
    s_lshl_b32 s46, s42, 8
    s_add_u32 s44, s48, s46
    buffer_load_dwordx4 v[104:107], v32, s[12:15], s44 offen
    s_add_u32 s44, s44, 32768
    buffer_load_dwordx4 v[108:111], v32, s[12:15], s44 offen
    s_add_u32 s44, s44, 32768
    buffer_load_dwordx4 v[112:115], v32, s[12:15], s44 offen
    s_add_u32 s44, s44, 32768
    s_mul_i32 s46, s42, 163840
    s_add_u32 s20, s72, s46
    s_addc_u32 s21, s73, 0
    s_mov_b32 s22, 163840
    s_mov_b32 s23, 0x20000
    s_cmp_lt_u32 s36, 27
    s_cselect_b32 s47, s36, 0
    s_cselect_b32 s26, 81920, 0
    s_cselect_b32 s38, 110592, 0
    s_cselect_b32 s59, -1, 0
    s_mov_b32 s39, 0
    s_mul_i32 s46, s47, 81920
    s_add_u32 s24, s80, s46
    s_addc_u32 s25, s81, 0
    s_mov_b32 s27, 0x20000
    s_mov_b32 s28, s86
    s_mov_b32 s29, s87
    s_mov_b32 s30, 0x300000
    s_mov_b32 s31, 0x20000
    s_mov_b32 s32, s82
    s_mov_b32 s33, s83
    s_movk_i32 s34, 10240
    s_mov_b32 s35, 0x20000
    s_mov_b32 s50, 0xffff0000
    s_mov_b32 s51, 0x3db504f3
    s_mov_b32 s52, 0x3fb8aa3b
    s_mov_b32 s53, 0x05040100
    s_mov_b32 s54, 0x07060302
    s_lshl_b32 s49, s40, 10
    v_mov_b32 v2, 131072
    v_mov_b32 v3, 1
    v_mov_b32 v20, 0
    v_mov_b32 v21, 0
    s_lshl_b32 s46, s40, 9
    s_add_u32 s46, s46, 135296
    v_lshl_add_u32 v22, v28, 3, s46
    ds_write_b64 v22, v[20:21]
    ds_write_b64 v2, v[20:21]
    v_lshlrev_b32 v24, 3, v30
    v_lshl_add_u32 v24, v29, 1, v24
    v_mul_u32_u24 v25, 43, v24
    v_lshrrev_b32 v25, 9, v25
    v_mul_u32_u24 v26, 12, v25
    v_sub_u32 v26, v24, v26
    v_lshlrev_b32 v36, 2, v25
    v_cmp_lt_u32 vcc, 5, v26
    s_nop 1
    v_cndmask_b32 v25, 0, 1, vcc
    v_lshl_add_u32 v36, v25, 1, v36
    v_mul_u32_u24 v25, 6, v25
    v_sub_u32 v26, v26, v25
    v_mul_u32_u24 v26, 48, v26
    v_add3_u32 v36, v36, v26, s46
    v_add_u32 v24, 1, v24
    v_mul_u32_u24 v25, 43, v24
    v_lshrrev_b32 v25, 9, v25
    v_mul_u32_u24 v26, 12, v25
    v_sub_u32 v26, v24, v26
    v_lshlrev_b32 v37, 2, v25
    v_cmp_lt_u32 vcc, 5, v26
    s_nop 1
    v_cndmask_b32 v25, 0, 1, vcc
    v_lshl_add_u32 v37, v25, 1, v37
    v_mul_u32_u24 v25, 6, v25
    v_sub_u32 v26, v26, v25
    v_mul_u32_u24 v26, 48, v26
    v_add3_u32 v37, v37, v26, s46
    v_mul_u32_u24 v25, 43, v28
    v_lshrrev_b32 v25, 9, v25
    v_mul_u32_u24 v26, 12, v25
    v_sub_u32 v26, v28, v26
    v_lshlrev_b32 v38, 2, v25
    v_cmp_lt_u32 vcc, 5, v26
    s_nop 1
    v_cndmask_b32 v25, 0, 1, vcc
    v_lshl_add_u32 v38, v25, 1, v38
    v_mul_u32_u24 v25, 6, v25
    v_sub_u32 v26, v26, v25
    v_mul_u32_u24 v26, 48, v26
    v_add3_u32 v38, v38, v26, s46
    v_mul_u32_u24 v24, 205, v0
    v_lshrrev_b32 v24, 14, v24
    v_mul_u32_u24 v25, 48, v24
    v_add_u32 v39, s46, v25
    s_lshl_b32 s48, s40, 2
    v_add_u32 v24, s48, v29
    v_mul_u32_u24 v24, 3456, v24
    v_and_b32 v25, 7, v28
    v_lshl_add_u32 v24, v25, 4, v24
    s_lshl_b32 s48, s47, 7
    v_add_u32 v24, s48, v24
    v_and_b32 v24, s59, v24
    v_mov_b32 v25, 0
    v_and_b32 v26, 8, v28
    v_cmp_eq_u32 vcc, 0, v26
    v_mov_b32 v34, s76
    v_mov_b32 v35, s77
    v_mov_b32 v26, s78
    v_mov_b32 v27, s79
    v_cndmask_b32 v34, v26, v34, vcc
    v_cndmask_b32 v35, v27, v35, vcc
    v_lshl_add_u64 v[34:35], v[24:25], 0, v[34:35]
    v_lshlrev_b32 v33, 5, v30
    v_lshl_add_u32 v33, v29, 3, v33
    v_add_u32 v33, 131136, v33
    buffer_load_dwordx4 v[56:59], v1, s[8:11], s43 offen offset:0 sc0 sc1 nt
    buffer_load_dwordx4 v[60:63], v1, s[8:11], s43 offen offset:1024 sc0 sc1 nt
    buffer_load_dwordx4 v[64:67], v1, s[8:11], s43 offen offset:2048 sc0 sc1 nt
    buffer_load_dwordx4 v[68:71], v1, s[8:11], s43 offen offset:3072 sc0 sc1 nt
    buffer_load_dwordx4 v[116:119], v32, s[12:15], s44 offen
    s_add_u32 s44, s44, 32768
    buffer_load_dwordx4 v[120:123], v32, s[12:15], s44 offen
    s_add_u32 s44, s44, 32768
    buffer_load_dwordx4 v[124:127], v32, s[12:15], s44 offen
    s_add_u32 s44, s44, 32768
    s_waitcnt vmcnt(14)
    v_add_u32 v15, 156032, v31
    ds_write2st64_b32 v15, v8, v9 offset0:0 offset1:1
    ds_write2st64_b32 v15, v10, v11 offset0:2 offset1:3
    ds_write_b32 v15, v12 offset:1024
    v_lshlrev_b32 v184, 16, v8
    v_and_b32 v185, s50, v8
    v_lshlrev_b32 v186, 16, v9
    v_and_b32 v187, s50, v9
    v_lshlrev_b32 v188, 16, v10
    v_and_b32 v189, s50, v10
    v_lshlrev_b32 v190, 16, v11
    v_and_b32 v191, s50, v11
    v_lshlrev_b32 v16, 16, v12
    v_and_b32 v17, s50, v12
    v_lshlrev_b32 v13, 16, v13
    v_lshlrev_b32 v14, 16, v14
    v_readlane_b32 s59, v184, 0
    v_mov_b32 v20, 0x3acccccd
    s_nop 0
    v_subrev_f32 v184, s59, v184
    v_subrev_f32 v185, s59, v185
    v_subrev_f32 v186, s59, v186
    v_subrev_f32 v187, s59, v187
    v_subrev_f32 v188, s59, v188
    v_subrev_f32 v189, s59, v189
    v_subrev_f32 v190, s59, v190
    v_subrev_f32 v191, s59, v191
    v_subrev_f32 v16, s59, v16
    v_subrev_f32 v17, s59, v17
    v_add_f32 v18, v184, v185
    v_mul_f32 v19, v184, v184
    v_fmac_f32 v19, v185, v185
    v_add_f32 v18, v18, v186
    v_fmac_f32 v19, v186, v186
    v_add_f32 v18, v18, v187
    v_fmac_f32 v19, v187, v187
    v_add_f32 v18, v18, v188
    v_fmac_f32 v19, v188, v188
    v_add_f32 v18, v18, v189
    v_fmac_f32 v19, v189, v189
    v_add_f32 v18, v18, v190
    v_fmac_f32 v19, v190, v190
    v_add_f32 v18, v18, v191
    v_fmac_f32 v19, v191, v191
    v_add_f32 v18, v18, v16
    v_fmac_f32 v19, v16, v16
    v_add_f32 v18, v18, v17
    v_fmac_f32 v19, v17, v17
    s_nop 0
    v_add_f32_dpp v18, v18, v18 row_ror:8 row_mask:0xf bank_mask:0xf
    v_add_f32_dpp v19, v19, v19 row_ror:8 row_mask:0xf bank_mask:0xf
    s_nop 0
    v_add_f32_dpp v18, v18, v18 row_ror:4 row_mask:0xf bank_mask:0xf
    v_add_f32_dpp v19, v19, v19 row_ror:4 row_mask:0xf bank_mask:0xf
    s_nop 0
    v_add_f32_dpp v18, v18, v18 row_ror:2 row_mask:0xf bank_mask:0xf
    v_add_f32_dpp v19, v19, v19 row_ror:2 row_mask:0xf bank_mask:0xf
    s_nop 0
    v_add_f32_dpp v18, v18, v18 row_ror:1 row_mask:0xf bank_mask:0xf
    v_add_f32_dpp v19, v19, v19 row_ror:1 row_mask:0xf bank_mask:0xf
    s_nop 1
    v_permlane32_swap_b32 v18, v19
    v_add_f32 v18, v18, v19
    v_mov_b32 v19, v18
    s_nop 1
    v_permlane16_swap_b32 v18, v19
    v_add_f32 v18, v18, v19
    v_mul_f32 v18, v18, v20
    v_mov_b32 v19, v18
    s_nop 1
    v_permlane32_swap_b32 v18, v19
    v_fma_f32 v19, -v18, v18, v19
    v_add_f32 v18, s59, v18
    v_max_f32 v19, 0, v19
    v_cvt_pk_bf16_f32 v18, v18, v18
    v_cvt_pk_bf16_f32 v19, v19, v19
    v_and_b32 v18, s50, v18
    v_and_b32 v19, s50, v19
    v_add_f32 v19, 0x3727c5ac, v19
    v_cvt_pk_bf16_f32 v19, v19, v19
    v_and_b32 v19, s50, v19
    v_sqrt_f32 v19, v19
    s_nop 0
    v_cvt_pk_bf16_f32 v19, v19, v19
    v_and_b32 v19, s50, v19
    v_rcp_f32 v20, v19
    v_sub_f32 v13, v13, v18
    v_sub_f32 v14, v14, v18
    v_cvt_pk_bf16_f32 v13, v13, v13
    v_cvt_pk_bf16_f32 v14, v14, v14
    v_and_b32 v13, s50, v13
    v_and_b32 v14, s50, v14
    v_mul_f32 v22, v13, v20
    v_mul_f32 v23, v14, v20
    v_fma_f32 v13, -v22, v19, v13
    v_fma_f32 v14, -v23, v19, v14
    v_fma_f32 v13, v13, v20, v22
    v_fma_f32 v14, v14, v20, v23
    v_cvt_pk_bf16_f32 v24, v13, 0
    v_cvt_pk_bf16_f32 v25, 0, v13
    v_cvt_pk_bf16_f32 v26, v14, 0
    v_cvt_pk_bf16_f32 v27, 0, v14
    v_mov_b32 v8, 0
    v_mov_b32 v9, 0
    v_mov_b32 v10, 0
    v_mov_b32 v11, 0
    v_mov_b32 v12, 0
    v_mov_b32 v13, 0
    v_mov_b32 v14, 0
    v_mov_b32 v15, 0
    s_add_u32 s43, s43, 32768
    buffer_load_dwordx4 v[72:75], v1, s[4:7], s43 offen offset:0 sc0 sc1 nt
    buffer_load_dwordx4 v[76:79], v1, s[4:7], s43 offen offset:1024 sc0 sc1 nt
    buffer_load_dwordx4 v[80:83], v1, s[4:7], s43 offen offset:2048 sc0 sc1 nt
    buffer_load_dwordx4 v[84:87], v1, s[4:7], s43 offen offset:3072 sc0 sc1 nt
    buffer_load_dwordx4 v[128:131], v32, s[12:15], s44 offen
    s_add_u32 s44, s44, 32768
    buffer_load_dwordx4 v[132:135], v32, s[12:15], s44 offen
    s_add_u32 s44, s44, 32768
    buffer_load_dwordx4 v[136:139], v32, s[12:15], s44 offen
    s_add_u32 s44, s44, 32768
    s_waitcnt vmcnt(14)
    v_dot2c_f32_bf16_dpp v8, v24, v104 row_newbcast:0 row_mask:0xf bank_mask:0xf
    v_dot2c_f32_bf16_dpp v9, v25, v104 row_newbcast:0 row_mask:0xf bank_mask:0xf
    v_dot2c_f32_bf16_dpp v10, v24, v105 row_newbcast:0 row_mask:0xf bank_mask:0xf
    v_dot2c_f32_bf16_dpp v11, v25, v105 row_newbcast:0 row_mask:0xf bank_mask:0xf
    v_dot2c_f32_bf16_dpp v12, v24, v106 row_newbcast:0 row_mask:0xf bank_mask:0xf
    v_dot2c_f32_bf16_dpp v13, v25, v106 row_newbcast:0 row_mask:0xf bank_mask:0xf
    v_dot2c_f32_bf16_dpp v14, v24, v107 row_newbcast:0 row_mask:0xf bank_mask:0xf
    v_dot2c_f32_bf16_dpp v15, v25, v107 row_newbcast:0 row_mask:0xf bank_mask:0xf
    v_dot2c_f32_bf16_dpp v8, v24, v108 row_newbcast:1 row_mask:0xf bank_mask:0xf
    v_dot2c_f32_bf16_dpp v9, v25, v108 row_newbcast:1 row_mask:0xf bank_mask:0xf
    v_dot2c_f32_bf16_dpp v10, v24, v109 row_newbcast:1 row_mask:0xf bank_mask:0xf
    v_dot2c_f32_bf16_dpp v11, v25, v109 row_newbcast:1 row_mask:0xf bank_mask:0xf
    v_dot2c_f32_bf16_dpp v12, v24, v110 row_newbcast:1 row_mask:0xf bank_mask:0xf
    v_dot2c_f32_bf16_dpp v13, v25, v110 row_newbcast:1 row_mask:0xf bank_mask:0xf
    v_dot2c_f32_bf16_dpp v14, v24, v111 row_newbcast:1 row_mask:0xf bank_mask:0xf
    v_dot2c_f32_bf16_dpp v15, v25, v111 row_newbcast:1 row_mask:0xf bank_mask:0xf
    v_dot2c_f32_bf16_dpp v8, v24, v112 row_newbcast:2 row_mask:0xf bank_mask:0xf
    v_dot2c_f32_bf16_dpp v9, v25, v112 row_newbcast:2 row_mask:0xf bank_mask:0xf
    v_dot2c_f32_bf16_dpp v10, v24, v113 row_newbcast:2 row_mask:0xf bank_mask:0xf
    v_dot2c_f32_bf16_dpp v11, v25, v113 row_newbcast:2 row_mask:0xf bank_mask:0xf
    v_dot2c_f32_bf16_dpp v12, v24, v114 row_newbcast:2 row_mask:0xf bank_mask:0xf
    v_dot2c_f32_bf16_dpp v13, v25, v114 row_newbcast:2 row_mask:0xf bank_mask:0xf
    v_dot2c_f32_bf16_dpp v14, v24, v115 row_newbcast:2 row_mask:0xf bank_mask:0xf
    v_dot2c_f32_bf16_dpp v15, v25, v115 row_newbcast:2 row_mask:0xf bank_mask:0xf
    buffer_load_dwordx4 v[88:91], v1, s[8:11], s43 offen offset:0 sc0 sc1 nt
    buffer_load_dwordx4 v[92:95], v1, s[8:11], s43 offen offset:1024 sc0 sc1 nt
    buffer_load_dwordx4 v[96:99], v1, s[8:11], s43 offen offset:2048 sc0 sc1 nt
    buffer_load_dwordx4 v[100:103], v1, s[8:11], s43 offen offset:3072 sc0 sc1 nt
    buffer_load_dwordx4 v[140:143], v32, s[12:15], s44 offen
    s_add_u32 s44, s44, 32768
    buffer_load_dwordx4 v[144:147], v32, s[12:15], s44 offen
    s_add_u32 s44, s44, 32768
    buffer_load_dwordx4 v[148:151], v32, s[12:15], s44 offen
    s_add_u32 s44, s44, 32768
    s_waitcnt vmcnt(14)
    v_dot2c_f32_bf16_dpp v8, v24, v116 row_newbcast:3 row_mask:0xf bank_mask:0xf
    v_dot2c_f32_bf16_dpp v9, v25, v116 row_newbcast:3 row_mask:0xf bank_mask:0xf
    v_dot2c_f32_bf16_dpp v10, v24, v117 row_newbcast:3 row_mask:0xf bank_mask:0xf
    v_dot2c_f32_bf16_dpp v11, v25, v117 row_newbcast:3 row_mask:0xf bank_mask:0xf
    v_dot2c_f32_bf16_dpp v12, v24, v118 row_newbcast:3 row_mask:0xf bank_mask:0xf
    v_dot2c_f32_bf16_dpp v13, v25, v118 row_newbcast:3 row_mask:0xf bank_mask:0xf
    v_dot2c_f32_bf16_dpp v14, v24, v119 row_newbcast:3 row_mask:0xf bank_mask:0xf
    v_dot2c_f32_bf16_dpp v15, v25, v119 row_newbcast:3 row_mask:0xf bank_mask:0xf
    v_dot2c_f32_bf16_dpp v8, v24, v120 row_newbcast:4 row_mask:0xf bank_mask:0xf
    v_dot2c_f32_bf16_dpp v9, v25, v120 row_newbcast:4 row_mask:0xf bank_mask:0xf
    v_dot2c_f32_bf16_dpp v10, v24, v121 row_newbcast:4 row_mask:0xf bank_mask:0xf
    v_dot2c_f32_bf16_dpp v11, v25, v121 row_newbcast:4 row_mask:0xf bank_mask:0xf
    v_dot2c_f32_bf16_dpp v12, v24, v122 row_newbcast:4 row_mask:0xf bank_mask:0xf
    v_dot2c_f32_bf16_dpp v13, v25, v122 row_newbcast:4 row_mask:0xf bank_mask:0xf
    v_dot2c_f32_bf16_dpp v14, v24, v123 row_newbcast:4 row_mask:0xf bank_mask:0xf
    v_dot2c_f32_bf16_dpp v15, v25, v123 row_newbcast:4 row_mask:0xf bank_mask:0xf
    v_dot2c_f32_bf16_dpp v8, v24, v124 row_newbcast:5 row_mask:0xf bank_mask:0xf
    v_dot2c_f32_bf16_dpp v9, v25, v124 row_newbcast:5 row_mask:0xf bank_mask:0xf
    v_dot2c_f32_bf16_dpp v10, v24, v125 row_newbcast:5 row_mask:0xf bank_mask:0xf
    v_dot2c_f32_bf16_dpp v11, v25, v125 row_newbcast:5 row_mask:0xf bank_mask:0xf
    v_dot2c_f32_bf16_dpp v12, v24, v126 row_newbcast:5 row_mask:0xf bank_mask:0xf
    v_dot2c_f32_bf16_dpp v13, v25, v126 row_newbcast:5 row_mask:0xf bank_mask:0xf
    v_dot2c_f32_bf16_dpp v14, v24, v127 row_newbcast:5 row_mask:0xf bank_mask:0xf
    v_dot2c_f32_bf16_dpp v15, v25, v127 row_newbcast:5 row_mask:0xf bank_mask:0xf
    s_add_u32 s43, s43, 32768
    buffer_load_dwordx4 v[192:195], v1, s[4:7], s43 offen offset:0 sc0 sc1 nt
    buffer_load_dwordx4 v[196:199], v1, s[4:7], s43 offen offset:1024 sc0 sc1 nt
    buffer_load_dwordx4 v[200:203], v1, s[4:7], s43 offen offset:2048 sc0 sc1 nt
    buffer_load_dwordx4 v[204:207], v1, s[4:7], s43 offen offset:3072 sc0 sc1 nt
    buffer_load_dwordx4 v[152:155], v32, s[12:15], s44 offen
    s_add_u32 s44, s44, 32768
    buffer_load_dwordx4 v[156:159], v32, s[12:15], s44 offen
    s_add_u32 s44, s44, 32768
    buffer_load_dwordx4 v[160:163], v32, s[12:15], s44 offen
    s_add_u32 s44, s44, 32768
    s_waitcnt vmcnt(14)
    v_dot2c_f32_bf16_dpp v8, v24, v128 row_newbcast:6 row_mask:0xf bank_mask:0xf
    v_dot2c_f32_bf16_dpp v9, v25, v128 row_newbcast:6 row_mask:0xf bank_mask:0xf
    v_dot2c_f32_bf16_dpp v10, v24, v129 row_newbcast:6 row_mask:0xf bank_mask:0xf
    v_dot2c_f32_bf16_dpp v11, v25, v129 row_newbcast:6 row_mask:0xf bank_mask:0xf
    v_dot2c_f32_bf16_dpp v12, v24, v130 row_newbcast:6 row_mask:0xf bank_mask:0xf
    v_dot2c_f32_bf16_dpp v13, v25, v130 row_newbcast:6 row_mask:0xf bank_mask:0xf
    v_dot2c_f32_bf16_dpp v14, v24, v131 row_newbcast:6 row_mask:0xf bank_mask:0xf
    v_dot2c_f32_bf16_dpp v15, v25, v131 row_newbcast:6 row_mask:0xf bank_mask:0xf
    v_dot2c_f32_bf16_dpp v8, v24, v132 row_newbcast:7 row_mask:0xf bank_mask:0xf
    v_dot2c_f32_bf16_dpp v9, v25, v132 row_newbcast:7 row_mask:0xf bank_mask:0xf
    v_dot2c_f32_bf16_dpp v10, v24, v133 row_newbcast:7 row_mask:0xf bank_mask:0xf
    v_dot2c_f32_bf16_dpp v11, v25, v133 row_newbcast:7 row_mask:0xf bank_mask:0xf
    v_dot2c_f32_bf16_dpp v12, v24, v134 row_newbcast:7 row_mask:0xf bank_mask:0xf
    v_dot2c_f32_bf16_dpp v13, v25, v134 row_newbcast:7 row_mask:0xf bank_mask:0xf
    v_dot2c_f32_bf16_dpp v14, v24, v135 row_newbcast:7 row_mask:0xf bank_mask:0xf
    v_dot2c_f32_bf16_dpp v15, v25, v135 row_newbcast:7 row_mask:0xf bank_mask:0xf
    v_dot2c_f32_bf16_dpp v8, v24, v136 row_newbcast:8 row_mask:0xf bank_mask:0xf
    v_dot2c_f32_bf16_dpp v9, v25, v136 row_newbcast:8 row_mask:0xf bank_mask:0xf
    v_dot2c_f32_bf16_dpp v10, v24, v137 row_newbcast:8 row_mask:0xf bank_mask:0xf
    v_dot2c_f32_bf16_dpp v11, v25, v137 row_newbcast:8 row_mask:0xf bank_mask:0xf
    v_dot2c_f32_bf16_dpp v12, v24, v138 row_newbcast:8 row_mask:0xf bank_mask:0xf
    v_dot2c_f32_bf16_dpp v13, v25, v138 row_newbcast:8 row_mask:0xf bank_mask:0xf
    v_dot2c_f32_bf16_dpp v14, v24, v139 row_newbcast:8 row_mask:0xf bank_mask:0xf
    v_dot2c_f32_bf16_dpp v15, v25, v139 row_newbcast:8 row_mask:0xf bank_mask:0xf
    buffer_load_dwordx4 v[208:211], v1, s[8:11], s43 offen offset:0 sc0 sc1 nt
    buffer_load_dwordx4 v[212:215], v1, s[8:11], s43 offen offset:1024 sc0 sc1 nt
    buffer_load_dwordx4 v[216:219], v1, s[8:11], s43 offen offset:2048 sc0 sc1 nt
    buffer_load_dwordx4 v[220:223], v1, s[8:11], s43 offen offset:3072 sc0 sc1 nt
    buffer_load_dwordx4 v[164:167], v32, s[12:15], s44 offen
    s_add_u32 s44, s44, 32768
    buffer_load_dwordx4 v[168:171], v32, s[12:15], s44 offen
    s_add_u32 s44, s44, 32768
    buffer_load_dwordx4 v[172:175], v32, s[12:15], s44 offen
    s_add_u32 s44, s44, 32768
    s_waitcnt vmcnt(14)
    v_dot2c_f32_bf16_dpp v8, v24, v140 row_newbcast:9 row_mask:0xf bank_mask:0xf
    v_dot2c_f32_bf16_dpp v9, v25, v140 row_newbcast:9 row_mask:0xf bank_mask:0xf
    v_dot2c_f32_bf16_dpp v10, v24, v141 row_newbcast:9 row_mask:0xf bank_mask:0xf
    v_dot2c_f32_bf16_dpp v11, v25, v141 row_newbcast:9 row_mask:0xf bank_mask:0xf
    v_dot2c_f32_bf16_dpp v12, v24, v142 row_newbcast:9 row_mask:0xf bank_mask:0xf
    v_dot2c_f32_bf16_dpp v13, v25, v142 row_newbcast:9 row_mask:0xf bank_mask:0xf
    v_dot2c_f32_bf16_dpp v14, v24, v143 row_newbcast:9 row_mask:0xf bank_mask:0xf
    v_dot2c_f32_bf16_dpp v15, v25, v143 row_newbcast:9 row_mask:0xf bank_mask:0xf
    v_dot2c_f32_bf16_dpp v8, v24, v144 row_newbcast:10 row_mask:0xf bank_mask:0xf
    v_dot2c_f32_bf16_dpp v9, v25, v144 row_newbcast:10 row_mask:0xf bank_mask:0xf
    v_dot2c_f32_bf16_dpp v10, v24, v145 row_newbcast:10 row_mask:0xf bank_mask:0xf
    v_dot2c_f32_bf16_dpp v11, v25, v145 row_newbcast:10 row_mask:0xf bank_mask:0xf
    v_dot2c_f32_bf16_dpp v12, v24, v146 row_newbcast:10 row_mask:0xf bank_mask:0xf
    v_dot2c_f32_bf16_dpp v13, v25, v146 row_newbcast:10 row_mask:0xf bank_mask:0xf
    v_dot2c_f32_bf16_dpp v14, v24, v147 row_newbcast:10 row_mask:0xf bank_mask:0xf
    v_dot2c_f32_bf16_dpp v15, v25, v147 row_newbcast:10 row_mask:0xf bank_mask:0xf
    v_dot2c_f32_bf16_dpp v8, v24, v148 row_newbcast:11 row_mask:0xf bank_mask:0xf
    v_dot2c_f32_bf16_dpp v9, v25, v148 row_newbcast:11 row_mask:0xf bank_mask:0xf
    v_dot2c_f32_bf16_dpp v10, v24, v149 row_newbcast:11 row_mask:0xf bank_mask:0xf
    v_dot2c_f32_bf16_dpp v11, v25, v149 row_newbcast:11 row_mask:0xf bank_mask:0xf
    v_dot2c_f32_bf16_dpp v12, v24, v150 row_newbcast:11 row_mask:0xf bank_mask:0xf
    v_dot2c_f32_bf16_dpp v13, v25, v150 row_newbcast:11 row_mask:0xf bank_mask:0xf
    v_dot2c_f32_bf16_dpp v14, v24, v151 row_newbcast:11 row_mask:0xf bank_mask:0xf
    v_dot2c_f32_bf16_dpp v15, v25, v151 row_newbcast:11 row_mask:0xf bank_mask:0xf
    s_add_u32 s43, s43, 32768
    buffer_load_dwordx4 v[224:227], v1, s[4:7], s43 offen offset:0 sc0 sc1 nt
    buffer_load_dwordx4 v[228:231], v1, s[4:7], s43 offen offset:1024 sc0 sc1 nt
    buffer_load_dwordx4 v[232:235], v1, s[4:7], s43 offen offset:2048 sc0 sc1 nt
    buffer_load_dwordx4 v[236:239], v1, s[4:7], s43 offen offset:3072 sc0 sc1 nt
    buffer_load_dwordx4 v[176:179], v32, s[12:15], s44 offen
    s_add_u32 s44, s44, 32768
    buffer_load_dwordx4 v[180:183], v32, s[12:15], s44 offen
    s_waitcnt vmcnt(13)
    v_dot2c_f32_bf16_dpp v8, v24, v152 row_newbcast:12 row_mask:0xf bank_mask:0xf
    v_dot2c_f32_bf16_dpp v9, v25, v152 row_newbcast:12 row_mask:0xf bank_mask:0xf
    v_dot2c_f32_bf16_dpp v10, v24, v153 row_newbcast:12 row_mask:0xf bank_mask:0xf
    v_dot2c_f32_bf16_dpp v11, v25, v153 row_newbcast:12 row_mask:0xf bank_mask:0xf
    v_dot2c_f32_bf16_dpp v12, v24, v154 row_newbcast:12 row_mask:0xf bank_mask:0xf
    v_dot2c_f32_bf16_dpp v13, v25, v154 row_newbcast:12 row_mask:0xf bank_mask:0xf
    v_dot2c_f32_bf16_dpp v14, v24, v155 row_newbcast:12 row_mask:0xf bank_mask:0xf
    v_dot2c_f32_bf16_dpp v15, v25, v155 row_newbcast:12 row_mask:0xf bank_mask:0xf
    v_dot2c_f32_bf16_dpp v8, v24, v156 row_newbcast:13 row_mask:0xf bank_mask:0xf
    v_dot2c_f32_bf16_dpp v9, v25, v156 row_newbcast:13 row_mask:0xf bank_mask:0xf
    v_dot2c_f32_bf16_dpp v10, v24, v157 row_newbcast:13 row_mask:0xf bank_mask:0xf
    v_dot2c_f32_bf16_dpp v11, v25, v157 row_newbcast:13 row_mask:0xf bank_mask:0xf
    v_dot2c_f32_bf16_dpp v12, v24, v158 row_newbcast:13 row_mask:0xf bank_mask:0xf
    v_dot2c_f32_bf16_dpp v13, v25, v158 row_newbcast:13 row_mask:0xf bank_mask:0xf
    v_dot2c_f32_bf16_dpp v14, v24, v159 row_newbcast:13 row_mask:0xf bank_mask:0xf
    v_dot2c_f32_bf16_dpp v15, v25, v159 row_newbcast:13 row_mask:0xf bank_mask:0xf
    v_dot2c_f32_bf16_dpp v8, v24, v160 row_newbcast:14 row_mask:0xf bank_mask:0xf
    v_dot2c_f32_bf16_dpp v9, v25, v160 row_newbcast:14 row_mask:0xf bank_mask:0xf
    v_dot2c_f32_bf16_dpp v10, v24, v161 row_newbcast:14 row_mask:0xf bank_mask:0xf
    v_dot2c_f32_bf16_dpp v11, v25, v161 row_newbcast:14 row_mask:0xf bank_mask:0xf
    v_dot2c_f32_bf16_dpp v12, v24, v162 row_newbcast:14 row_mask:0xf bank_mask:0xf
    v_dot2c_f32_bf16_dpp v13, v25, v162 row_newbcast:14 row_mask:0xf bank_mask:0xf
    v_dot2c_f32_bf16_dpp v14, v24, v163 row_newbcast:14 row_mask:0xf bank_mask:0xf
    v_dot2c_f32_bf16_dpp v15, v25, v163 row_newbcast:14 row_mask:0xf bank_mask:0xf
    s_waitcnt vmcnt(6)
    v_dot2c_f32_bf16_dpp v8, v24, v164 row_newbcast:15 row_mask:0xf bank_mask:0xf
    v_dot2c_f32_bf16_dpp v9, v25, v164 row_newbcast:15 row_mask:0xf bank_mask:0xf
    v_dot2c_f32_bf16_dpp v10, v24, v165 row_newbcast:15 row_mask:0xf bank_mask:0xf
    v_dot2c_f32_bf16_dpp v11, v25, v165 row_newbcast:15 row_mask:0xf bank_mask:0xf
    v_dot2c_f32_bf16_dpp v12, v24, v166 row_newbcast:15 row_mask:0xf bank_mask:0xf
    v_dot2c_f32_bf16_dpp v13, v25, v166 row_newbcast:15 row_mask:0xf bank_mask:0xf
    v_dot2c_f32_bf16_dpp v14, v24, v167 row_newbcast:15 row_mask:0xf bank_mask:0xf
    v_dot2c_f32_bf16_dpp v15, v25, v167 row_newbcast:15 row_mask:0xf bank_mask:0xf
    v_dot2c_f32_bf16_dpp v8, v26, v168 row_newbcast:0 row_mask:0xf bank_mask:0xf
    v_dot2c_f32_bf16_dpp v9, v27, v168 row_newbcast:0 row_mask:0xf bank_mask:0xf
    v_dot2c_f32_bf16_dpp v10, v26, v169 row_newbcast:0 row_mask:0xf bank_mask:0xf
    v_dot2c_f32_bf16_dpp v11, v27, v169 row_newbcast:0 row_mask:0xf bank_mask:0xf
    v_dot2c_f32_bf16_dpp v12, v26, v170 row_newbcast:0 row_mask:0xf bank_mask:0xf
    v_dot2c_f32_bf16_dpp v13, v27, v170 row_newbcast:0 row_mask:0xf bank_mask:0xf
    v_dot2c_f32_bf16_dpp v14, v26, v171 row_newbcast:0 row_mask:0xf bank_mask:0xf
    v_dot2c_f32_bf16_dpp v15, v27, v171 row_newbcast:0 row_mask:0xf bank_mask:0xf
    v_dot2c_f32_bf16_dpp v8, v26, v172 row_newbcast:1 row_mask:0xf bank_mask:0xf
    v_dot2c_f32_bf16_dpp v9, v27, v172 row_newbcast:1 row_mask:0xf bank_mask:0xf
    v_dot2c_f32_bf16_dpp v10, v26, v173 row_newbcast:1 row_mask:0xf bank_mask:0xf
    v_dot2c_f32_bf16_dpp v11, v27, v173 row_newbcast:1 row_mask:0xf bank_mask:0xf
    v_dot2c_f32_bf16_dpp v12, v26, v174 row_newbcast:1 row_mask:0xf bank_mask:0xf
    v_dot2c_f32_bf16_dpp v13, v27, v174 row_newbcast:1 row_mask:0xf bank_mask:0xf
    v_dot2c_f32_bf16_dpp v14, v26, v175 row_newbcast:1 row_mask:0xf bank_mask:0xf
    v_dot2c_f32_bf16_dpp v15, v27, v175 row_newbcast:1 row_mask:0xf bank_mask:0xf
    s_waitcnt vmcnt(0)
    v_dot2c_f32_bf16_dpp v8, v26, v176 row_newbcast:2 row_mask:0xf bank_mask:0xf
    v_dot2c_f32_bf16_dpp v9, v27, v176 row_newbcast:2 row_mask:0xf bank_mask:0xf
    v_dot2c_f32_bf16_dpp v10, v26, v177 row_newbcast:2 row_mask:0xf bank_mask:0xf
    v_dot2c_f32_bf16_dpp v11, v27, v177 row_newbcast:2 row_mask:0xf bank_mask:0xf
    v_dot2c_f32_bf16_dpp v12, v26, v178 row_newbcast:2 row_mask:0xf bank_mask:0xf
    v_dot2c_f32_bf16_dpp v13, v27, v178 row_newbcast:2 row_mask:0xf bank_mask:0xf
    v_dot2c_f32_bf16_dpp v14, v26, v179 row_newbcast:2 row_mask:0xf bank_mask:0xf
    v_dot2c_f32_bf16_dpp v15, v27, v179 row_newbcast:2 row_mask:0xf bank_mask:0xf
    v_dot2c_f32_bf16_dpp v8, v26, v180 row_newbcast:3 row_mask:0xf bank_mask:0xf
    v_dot2c_f32_bf16_dpp v9, v27, v180 row_newbcast:3 row_mask:0xf bank_mask:0xf
    v_dot2c_f32_bf16_dpp v10, v26, v181 row_newbcast:3 row_mask:0xf bank_mask:0xf
    v_dot2c_f32_bf16_dpp v11, v27, v181 row_newbcast:3 row_mask:0xf bank_mask:0xf
    v_dot2c_f32_bf16_dpp v12, v26, v182 row_newbcast:3 row_mask:0xf bank_mask:0xf
    v_dot2c_f32_bf16_dpp v13, v27, v182 row_newbcast:3 row_mask:0xf bank_mask:0xf
    v_dot2c_f32_bf16_dpp v14, v26, v183 row_newbcast:3 row_mask:0xf bank_mask:0xf
    v_dot2c_f32_bf16_dpp v15, v27, v183 row_newbcast:3 row_mask:0xf bank_mask:0xf
    v_permlane32_swap_b32 v8, v12
    v_permlane32_swap_b32 v9, v13
    v_permlane32_swap_b32 v10, v14
    v_permlane32_swap_b32 v11, v15
    v_add_f32 v8, v8, v12
    v_add_f32 v9, v9, v13
    v_add_f32 v10, v10, v14
    v_add_f32 v11, v11, v15
    s_nop 0
    v_permlane16_swap_b32 v8, v10
    v_permlane16_swap_b32 v9, v11
    v_add_f32 v8, v8, v10
    v_add_f32 v9, v9, v11
    s_lshl_b32 s46, s40, 9
    v_add_u32 v24, s46, v33
    ds_write_b64 v24, v[8:9]
    s_setprio 0
    buffer_load_dwordx4 v[240:243], v1, s[8:11], s43 offen offset:0 sc0 sc1 nt
    buffer_load_dwordx4 v[244:247], v1, s[8:11], s43 offen offset:1024 sc0 sc1 nt
    buffer_load_dwordx4 v[248:251], v1, s[8:11], s43 offen offset:2048 sc0 sc1 nt
    buffer_load_dwordx4 v[252:255], v1, s[8:11], s43 offen offset:3072 sc0 sc1 nt
    s_setprio 3
    s_waitcnt lgkmcnt(0)
    s_barrier
    ds_read_b64 v[104:105], v33 offset:0
    ds_read_b64 v[106:107], v33 offset:512
    ds_read_b64 v[108:109], v33 offset:1024
    ds_read_b64 v[110:111], v33 offset:1536
    ds_read_b64 v[112:113], v33 offset:2048
    ds_read_b64 v[114:115], v33 offset:2560
    ds_read_b64 v[116:117], v33 offset:3072
    ds_read_b64 v[118:119], v33 offset:3584
    v_lshlrev_b32 v32, 4, v0
    v_cmp_gt_u32 vcc, 480, v0
    v_mov_b32 v24, 0x7fff0000
    s_nop 0
    v_cndmask_b32 v32, v24, v32, vcc
    v_mov_b32 v8, 0
    v_mov_b32 v9, 0
    v_mov_b32 v10, 0
    v_mov_b32 v11, 0
    v_mov_b32 v12, 0
    v_mov_b32 v13, 0
    v_mov_b32 v14, 0
    v_mov_b32 v15, 0
    v_mov_b32 v5, 0xff7fffff
    v_mov_b32 v6, 0
    s_waitcnt lgkmcnt(0)
    v_pk_add_f32 v[104:105], v[104:105], v[106:107]
    v_pk_add_f32 v[108:109], v[108:109], v[110:111]
    v_pk_add_f32 v[112:113], v[112:113], v[114:115]
    v_pk_add_f32 v[116:117], v[116:117], v[118:119]
    v_pk_add_f32 v[104:105], v[104:105], v[108:109]
    v_pk_add_f32 v[112:113], v[112:113], v[116:117]
    v_pk_add_f32 v[104:105], v[104:105], v[112:113]
    v_cvt_pk_bf16_f32 v16, v104, v105
    v_mov_b32 v18, v16
    s_nop 1
    v_permlane32_swap_b32 v16, v18
    v_mov_b32 v17, v16
    v_mov_b32 v19, v18
    s_nop 0
    v_permlane16_swap_b32 v16, v17
    v_permlane16_swap_b32 v18, v19
    v_dot2_f32_bf16 v20, v40, v16, 0
    v_dot2_f32_bf16 v21, v44, v16, 0
    v_dot2_f32_bf16 v22, v48, v16, 0
    v_dot2_f32_bf16 v23, v52, v16, 0
    v_dot2c_f32_bf16 v20, v41, v17
    v_dot2c_f32_bf16 v21, v45, v17
    v_dot2c_f32_bf16 v22, v49, v17
    v_dot2c_f32_bf16 v23, v53, v17
    v_dot2c_f32_bf16 v20, v42, v18
    v_dot2c_f32_bf16 v21, v46, v18
    v_dot2c_f32_bf16 v22, v50, v18
    v_dot2c_f32_bf16 v23, v54, v18
    v_dot2c_f32_bf16 v20, v43, v19
    v_dot2c_f32_bf16 v21, v47, v19
    v_dot2c_f32_bf16 v22, v51, v19
    v_dot2c_f32_bf16 v23, v55, v19
    s_mov_b32 s46, 0
    buffer_load_dwordx4 v[104:107], v32, s[20:23], s46 offen
    s_add_u32 s43, s43, 32768
    buffer_load_dwordx4 v[40:43], v1, s[4:7], s43 offen offset:0 sc0 sc1 nt
    buffer_load_dwordx4 v[44:47], v1, s[4:7], s43 offen offset:1024 sc0 sc1 nt
    buffer_load_dwordx4 v[48:51], v1, s[4:7], s43 offen offset:2048 sc0 sc1 nt
    buffer_load_dwordx4 v[52:55], v1, s[4:7], s43 offen offset:3072 sc0 sc1 nt
    v_add_f32_dpp v20, v20, v20 row_ror:8 row_mask:0xf bank_mask:0x3
    v_add_f32_dpp v22, v22, v22 row_ror:8 row_mask:0xf bank_mask:0x3
    s_nop 0
    v_add_f32_dpp v20, v21, v21 row_ror:8 row_mask:0xf bank_mask:0xc
    v_add_f32_dpp v22, v23, v23 row_ror:8 row_mask:0xf bank_mask:0xc
    s_nop 0
    v_add_f32_dpp v20, v20, v20 row_half_mirror row_mask:0xf bank_mask:0x5
    s_nop 1
    v_add_f32_dpp v20, v22, v22 row_half_mirror row_mask:0xf bank_mask:0xa
    s_nop 1
    v_add_f32_dpp v20, v20, v20 quad_perm:[1,0,3,2] row_mask:0xf bank_mask:0xf
    s_nop 1
    v_add_f32_dpp v20, v20, v20 quad_perm:[2,3,0,1] row_mask:0xf bank_mask:0xf
    v_cvt_pk_bf16_f32 v20, v20, v20
    v_and_b32 v20, s50, v20
    v_mul_f32 v20, s51, v20
    v_cvt_pk_bf16_f32 v20, v20, v20
    v_and_b32 v20, s50, v20
    s_nop 1
    v_max_f32_dpp v21, v20, v20 row_ror:4 row_mask:0xf bank_mask:0xf
    s_nop 1
    v_max_f32_dpp v21, v21, v21 row_ror:8 row_mask:0xf bank_mask:0xf
    v_max_f32 v21, v21, v5
    v_sub_f32 v22, v5, v21
    v_sub_f32 v20, v20, v21
    v_mov_b32 v5, v21
    v_mul_f32 v22, s52, v22
    v_mul_f32 v20, s52, v20
    v_exp_f32 v26, v22
    v_exp_f32 v20, v20
    v_pk_mul_f32 v[8:9], v[8:9], v[26:27] op_sel_hi:[1,0]
    v_pk_mul_f32 v[10:11], v[10:11], v[26:27] op_sel_hi:[1,0]
    v_pk_mul_f32 v[12:13], v[12:13], v[26:27] op_sel_hi:[1,0]
    v_pk_mul_f32 v[14:15], v[14:15], v[26:27] op_sel_hi:[1,0]
    v_cvt_pk_bf16_f32 v24, v20, 0
    v_cvt_pk_bf16_f32 v25, 0, v20
    v_fma_f32 v6, v6, v26, v20
    v_dot2c_f32_bf16_dpp v8, v24, v56 row_newbcast:0 row_mask:0xf bank_mask:0xf
    v_dot2c_f32_bf16_dpp v9, v25, v56 row_newbcast:0 row_mask:0xf bank_mask:0xf
    v_dot2c_f32_bf16_dpp v10, v24, v57 row_newbcast:0 row_mask:0xf bank_mask:0xf
    v_dot2c_f32_bf16_dpp v11, v25, v57 row_newbcast:0 row_mask:0xf bank_mask:0xf
    v_dot2c_f32_bf16_dpp v12, v24, v58 row_newbcast:0 row_mask:0xf bank_mask:0xf
    v_dot2c_f32_bf16_dpp v13, v25, v58 row_newbcast:0 row_mask:0xf bank_mask:0xf
    v_dot2c_f32_bf16_dpp v14, v24, v59 row_newbcast:0 row_mask:0xf bank_mask:0xf
    v_dot2c_f32_bf16_dpp v15, v25, v59 row_newbcast:0 row_mask:0xf bank_mask:0xf
    v_dot2c_f32_bf16_dpp v8, v24, v60 row_newbcast:8 row_mask:0xf bank_mask:0xf
    v_dot2c_f32_bf16_dpp v9, v25, v60 row_newbcast:8 row_mask:0xf bank_mask:0xf
    v_dot2c_f32_bf16_dpp v10, v24, v61 row_newbcast:8 row_mask:0xf bank_mask:0xf
    v_dot2c_f32_bf16_dpp v11, v25, v61 row_newbcast:8 row_mask:0xf bank_mask:0xf
    v_dot2c_f32_bf16_dpp v12, v24, v62 row_newbcast:8 row_mask:0xf bank_mask:0xf
    v_dot2c_f32_bf16_dpp v13, v25, v62 row_newbcast:8 row_mask:0xf bank_mask:0xf
    v_dot2c_f32_bf16_dpp v14, v24, v63 row_newbcast:8 row_mask:0xf bank_mask:0xf
    v_dot2c_f32_bf16_dpp v15, v25, v63 row_newbcast:8 row_mask:0xf bank_mask:0xf
    v_dot2c_f32_bf16_dpp v8, v24, v64 row_newbcast:4 row_mask:0xf bank_mask:0xf
    v_dot2c_f32_bf16_dpp v9, v25, v64 row_newbcast:4 row_mask:0xf bank_mask:0xf
    v_dot2c_f32_bf16_dpp v10, v24, v65 row_newbcast:4 row_mask:0xf bank_mask:0xf
    v_dot2c_f32_bf16_dpp v11, v25, v65 row_newbcast:4 row_mask:0xf bank_mask:0xf
    v_dot2c_f32_bf16_dpp v12, v24, v66 row_newbcast:4 row_mask:0xf bank_mask:0xf
    v_dot2c_f32_bf16_dpp v13, v25, v66 row_newbcast:4 row_mask:0xf bank_mask:0xf
    v_dot2c_f32_bf16_dpp v14, v24, v67 row_newbcast:4 row_mask:0xf bank_mask:0xf
    v_dot2c_f32_bf16_dpp v15, v25, v67 row_newbcast:4 row_mask:0xf bank_mask:0xf
    v_dot2c_f32_bf16_dpp v8, v24, v68 row_newbcast:12 row_mask:0xf bank_mask:0xf
    v_dot2c_f32_bf16_dpp v9, v25, v68 row_newbcast:12 row_mask:0xf bank_mask:0xf
    v_dot2c_f32_bf16_dpp v10, v24, v69 row_newbcast:12 row_mask:0xf bank_mask:0xf
    v_dot2c_f32_bf16_dpp v11, v25, v69 row_newbcast:12 row_mask:0xf bank_mask:0xf
    v_dot2c_f32_bf16_dpp v12, v24, v70 row_newbcast:12 row_mask:0xf bank_mask:0xf
    v_dot2c_f32_bf16_dpp v13, v25, v70 row_newbcast:12 row_mask:0xf bank_mask:0xf
    v_dot2c_f32_bf16_dpp v14, v24, v71 row_newbcast:12 row_mask:0xf bank_mask:0xf
    v_dot2c_f32_bf16_dpp v15, v25, v71 row_newbcast:12 row_mask:0xf bank_mask:0xf
    s_mov_b32 s46, 7680
    buffer_load_dwordx4 v[108:111], v32, s[20:23], s46 offen
    buffer_load_dwordx4 v[56:59], v1, s[8:11], s43 offen offset:0 sc0 sc1 nt
    buffer_load_dwordx4 v[60:63], v1, s[8:11], s43 offen offset:1024 sc0 sc1 nt
    buffer_load_dwordx4 v[64:67], v1, s[8:11], s43 offen offset:2048 sc0 sc1 nt
    buffer_load_dwordx4 v[68:71], v1, s[8:11], s43 offen offset:3072 sc0 sc1 nt
    v_dot2_f32_bf16 v20, v72, v16, 0
    v_dot2_f32_bf16 v21, v76, v16, 0
    v_dot2_f32_bf16 v22, v80, v16, 0
    v_dot2_f32_bf16 v23, v84, v16, 0
    v_dot2c_f32_bf16 v20, v73, v17
    v_dot2c_f32_bf16 v21, v77, v17
    v_dot2c_f32_bf16 v22, v81, v17
    v_dot2c_f32_bf16 v23, v85, v17
    v_dot2c_f32_bf16 v20, v74, v18
    v_dot2c_f32_bf16 v21, v78, v18
    v_dot2c_f32_bf16 v22, v82, v18
    v_dot2c_f32_bf16 v23, v86, v18
    v_dot2c_f32_bf16 v20, v75, v19
    v_dot2c_f32_bf16 v21, v79, v19
    v_dot2c_f32_bf16 v22, v83, v19
    v_dot2c_f32_bf16 v23, v87, v19
    s_mov_b32 s46, 15360
    buffer_load_dwordx4 v[112:115], v32, s[20:23], s46 offen
    s_add_u32 s43, s43, 32768
    buffer_load_dwordx4 v[72:75], v1, s[4:7], s43 offen offset:0 sc0 sc1 nt
    buffer_load_dwordx4 v[76:79], v1, s[4:7], s43 offen offset:1024 sc0 sc1 nt
    buffer_load_dwordx4 v[80:83], v1, s[4:7], s43 offen offset:2048 sc0 sc1 nt
    buffer_load_dwordx4 v[84:87], v1, s[4:7], s43 offen offset:3072 sc0 sc1 nt
    v_add_f32_dpp v20, v20, v20 row_ror:8 row_mask:0xf bank_mask:0x3
    v_add_f32_dpp v22, v22, v22 row_ror:8 row_mask:0xf bank_mask:0x3
    s_nop 0
    v_add_f32_dpp v20, v21, v21 row_ror:8 row_mask:0xf bank_mask:0xc
    v_add_f32_dpp v22, v23, v23 row_ror:8 row_mask:0xf bank_mask:0xc
    s_nop 0
    v_add_f32_dpp v20, v20, v20 row_half_mirror row_mask:0xf bank_mask:0x5
    s_nop 1
    v_add_f32_dpp v20, v22, v22 row_half_mirror row_mask:0xf bank_mask:0xa
    s_nop 1
    v_add_f32_dpp v20, v20, v20 quad_perm:[1,0,3,2] row_mask:0xf bank_mask:0xf
    s_nop 1
    v_add_f32_dpp v20, v20, v20 quad_perm:[2,3,0,1] row_mask:0xf bank_mask:0xf
    v_cvt_pk_bf16_f32 v20, v20, v20
    v_and_b32 v20, s50, v20
    v_mul_f32 v20, s51, v20
    v_cvt_pk_bf16_f32 v20, v20, v20
    v_and_b32 v20, s50, v20
    s_nop 1
    v_max_f32_dpp v21, v20, v20 row_ror:4 row_mask:0xf bank_mask:0xf
    s_nop 1
    v_max_f32_dpp v21, v21, v21 row_ror:8 row_mask:0xf bank_mask:0xf
    v_max_f32 v21, v21, v5
    v_sub_f32 v22, v5, v21
    v_sub_f32 v20, v20, v21
    v_mov_b32 v5, v21
    v_mul_f32 v22, s52, v22
    v_mul_f32 v20, s52, v20
    v_exp_f32 v26, v22
    v_exp_f32 v20, v20
    v_pk_mul_f32 v[8:9], v[8:9], v[26:27] op_sel_hi:[1,0]
    v_pk_mul_f32 v[10:11], v[10:11], v[26:27] op_sel_hi:[1,0]
    v_pk_mul_f32 v[12:13], v[12:13], v[26:27] op_sel_hi:[1,0]
    v_pk_mul_f32 v[14:15], v[14:15], v[26:27] op_sel_hi:[1,0]
    v_cvt_pk_bf16_f32 v24, v20, 0
    v_cvt_pk_bf16_f32 v25, 0, v20
    v_fma_f32 v6, v6, v26, v20
    v_dot2c_f32_bf16_dpp v8, v24, v88 row_newbcast:0 row_mask:0xf bank_mask:0xf
    v_dot2c_f32_bf16_dpp v9, v25, v88 row_newbcast:0 row_mask:0xf bank_mask:0xf
    v_dot2c_f32_bf16_dpp v10, v24, v89 row_newbcast:0 row_mask:0xf bank_mask:0xf
    v_dot2c_f32_bf16_dpp v11, v25, v89 row_newbcast:0 row_mask:0xf bank_mask:0xf
    v_dot2c_f32_bf16_dpp v12, v24, v90 row_newbcast:0 row_mask:0xf bank_mask:0xf
    v_dot2c_f32_bf16_dpp v13, v25, v90 row_newbcast:0 row_mask:0xf bank_mask:0xf
    v_dot2c_f32_bf16_dpp v14, v24, v91 row_newbcast:0 row_mask:0xf bank_mask:0xf
    v_dot2c_f32_bf16_dpp v15, v25, v91 row_newbcast:0 row_mask:0xf bank_mask:0xf
    v_dot2c_f32_bf16_dpp v8, v24, v92 row_newbcast:8 row_mask:0xf bank_mask:0xf
    v_dot2c_f32_bf16_dpp v9, v25, v92 row_newbcast:8 row_mask:0xf bank_mask:0xf
    v_dot2c_f32_bf16_dpp v10, v24, v93 row_newbcast:8 row_mask:0xf bank_mask:0xf
    v_dot2c_f32_bf16_dpp v11, v25, v93 row_newbcast:8 row_mask:0xf bank_mask:0xf
    v_dot2c_f32_bf16_dpp v12, v24, v94 row_newbcast:8 row_mask:0xf bank_mask:0xf
    v_dot2c_f32_bf16_dpp v13, v25, v94 row_newbcast:8 row_mask:0xf bank_mask:0xf
    v_dot2c_f32_bf16_dpp v14, v24, v95 row_newbcast:8 row_mask:0xf bank_mask:0xf
    v_dot2c_f32_bf16_dpp v15, v25, v95 row_newbcast:8 row_mask:0xf bank_mask:0xf
    v_dot2c_f32_bf16_dpp v8, v24, v96 row_newbcast:4 row_mask:0xf bank_mask:0xf
    v_dot2c_f32_bf16_dpp v9, v25, v96 row_newbcast:4 row_mask:0xf bank_mask:0xf
    v_dot2c_f32_bf16_dpp v10, v24, v97 row_newbcast:4 row_mask:0xf bank_mask:0xf
    v_dot2c_f32_bf16_dpp v11, v25, v97 row_newbcast:4 row_mask:0xf bank_mask:0xf
    v_dot2c_f32_bf16_dpp v12, v24, v98 row_newbcast:4 row_mask:0xf bank_mask:0xf
    v_dot2c_f32_bf16_dpp v13, v25, v98 row_newbcast:4 row_mask:0xf bank_mask:0xf
    v_dot2c_f32_bf16_dpp v14, v24, v99 row_newbcast:4 row_mask:0xf bank_mask:0xf
    v_dot2c_f32_bf16_dpp v15, v25, v99 row_newbcast:4 row_mask:0xf bank_mask:0xf
    v_dot2c_f32_bf16_dpp v8, v24, v100 row_newbcast:12 row_mask:0xf bank_mask:0xf
    v_dot2c_f32_bf16_dpp v9, v25, v100 row_newbcast:12 row_mask:0xf bank_mask:0xf
    v_dot2c_f32_bf16_dpp v10, v24, v101 row_newbcast:12 row_mask:0xf bank_mask:0xf
    v_dot2c_f32_bf16_dpp v11, v25, v101 row_newbcast:12 row_mask:0xf bank_mask:0xf
    v_dot2c_f32_bf16_dpp v12, v24, v102 row_newbcast:12 row_mask:0xf bank_mask:0xf
    v_dot2c_f32_bf16_dpp v13, v25, v102 row_newbcast:12 row_mask:0xf bank_mask:0xf
    v_dot2c_f32_bf16_dpp v14, v24, v103 row_newbcast:12 row_mask:0xf bank_mask:0xf
    v_dot2c_f32_bf16_dpp v15, v25, v103 row_newbcast:12 row_mask:0xf bank_mask:0xf
    s_mov_b32 s46, 23040
    buffer_load_dwordx4 v[116:119], v32, s[20:23], s46 offen
    buffer_load_dwordx4 v[88:91], v1, s[8:11], s43 offen offset:0 sc0 sc1 nt
    buffer_load_dwordx4 v[92:95], v1, s[8:11], s43 offen offset:1024 sc0 sc1 nt
    buffer_load_dwordx4 v[96:99], v1, s[8:11], s43 offen offset:2048 sc0 sc1 nt
    buffer_load_dwordx4 v[100:103], v1, s[8:11], s43 offen offset:3072 sc0 sc1 nt
    v_dot2_f32_bf16 v20, v192, v16, 0
    v_dot2_f32_bf16 v21, v196, v16, 0
    v_dot2_f32_bf16 v22, v200, v16, 0
    v_dot2_f32_bf16 v23, v204, v16, 0
    v_dot2c_f32_bf16 v20, v193, v17
    v_dot2c_f32_bf16 v21, v197, v17
    v_dot2c_f32_bf16 v22, v201, v17
    v_dot2c_f32_bf16 v23, v205, v17
    v_dot2c_f32_bf16 v20, v194, v18
    v_dot2c_f32_bf16 v21, v198, v18
    v_dot2c_f32_bf16 v22, v202, v18
    v_dot2c_f32_bf16 v23, v206, v18
    v_dot2c_f32_bf16 v20, v195, v19
    v_dot2c_f32_bf16 v21, v199, v19
    v_dot2c_f32_bf16 v22, v203, v19
    v_dot2c_f32_bf16 v23, v207, v19
    s_mov_b32 s46, 30720
    buffer_load_dwordx4 v[120:123], v32, s[20:23], s46 offen
    s_add_u32 s43, s43, 32768
    buffer_load_dwordx4 v[192:195], v1, s[4:7], s43 offen offset:0 sc0 sc1 nt
    buffer_load_dwordx4 v[196:199], v1, s[4:7], s43 offen offset:1024 sc0 sc1 nt
    buffer_load_dwordx4 v[200:203], v1, s[4:7], s43 offen offset:2048 sc0 sc1 nt
    buffer_load_dwordx4 v[204:207], v1, s[4:7], s43 offen offset:3072 sc0 sc1 nt
    v_add_f32_dpp v20, v20, v20 row_ror:8 row_mask:0xf bank_mask:0x3
    v_add_f32_dpp v22, v22, v22 row_ror:8 row_mask:0xf bank_mask:0x3
    s_nop 0
    v_add_f32_dpp v20, v21, v21 row_ror:8 row_mask:0xf bank_mask:0xc
    v_add_f32_dpp v22, v23, v23 row_ror:8 row_mask:0xf bank_mask:0xc
    s_nop 0
    v_add_f32_dpp v20, v20, v20 row_half_mirror row_mask:0xf bank_mask:0x5
    s_nop 1
    v_add_f32_dpp v20, v22, v22 row_half_mirror row_mask:0xf bank_mask:0xa
    s_nop 1
    v_add_f32_dpp v20, v20, v20 quad_perm:[1,0,3,2] row_mask:0xf bank_mask:0xf
    s_nop 1
    v_add_f32_dpp v20, v20, v20 quad_perm:[2,3,0,1] row_mask:0xf bank_mask:0xf
    v_cvt_pk_bf16_f32 v20, v20, v20
    v_and_b32 v20, s50, v20
    v_mul_f32 v20, s51, v20
    v_cvt_pk_bf16_f32 v20, v20, v20
    v_and_b32 v20, s50, v20
    s_nop 1
    v_max_f32_dpp v21, v20, v20 row_ror:4 row_mask:0xf bank_mask:0xf
    s_nop 1
    v_max_f32_dpp v21, v21, v21 row_ror:8 row_mask:0xf bank_mask:0xf
    v_max_f32 v21, v21, v5
    v_sub_f32 v22, v5, v21
    v_sub_f32 v20, v20, v21
    v_mov_b32 v5, v21
    v_mul_f32 v22, s52, v22
    v_mul_f32 v20, s52, v20
    v_exp_f32 v26, v22
    v_exp_f32 v20, v20
    v_pk_mul_f32 v[8:9], v[8:9], v[26:27] op_sel_hi:[1,0]
    v_pk_mul_f32 v[10:11], v[10:11], v[26:27] op_sel_hi:[1,0]
    v_pk_mul_f32 v[12:13], v[12:13], v[26:27] op_sel_hi:[1,0]
    v_pk_mul_f32 v[14:15], v[14:15], v[26:27] op_sel_hi:[1,0]
    v_cvt_pk_bf16_f32 v24, v20, 0
    v_cvt_pk_bf16_f32 v25, 0, v20
    v_fma_f32 v6, v6, v26, v20
    v_dot2c_f32_bf16_dpp v8, v24, v208 row_newbcast:0 row_mask:0xf bank_mask:0xf
    v_dot2c_f32_bf16_dpp v9, v25, v208 row_newbcast:0 row_mask:0xf bank_mask:0xf
    v_dot2c_f32_bf16_dpp v10, v24, v209 row_newbcast:0 row_mask:0xf bank_mask:0xf
    v_dot2c_f32_bf16_dpp v11, v25, v209 row_newbcast:0 row_mask:0xf bank_mask:0xf
    v_dot2c_f32_bf16_dpp v12, v24, v210 row_newbcast:0 row_mask:0xf bank_mask:0xf
    v_dot2c_f32_bf16_dpp v13, v25, v210 row_newbcast:0 row_mask:0xf bank_mask:0xf
    v_dot2c_f32_bf16_dpp v14, v24, v211 row_newbcast:0 row_mask:0xf bank_mask:0xf
    v_dot2c_f32_bf16_dpp v15, v25, v211 row_newbcast:0 row_mask:0xf bank_mask:0xf
    v_dot2c_f32_bf16_dpp v8, v24, v212 row_newbcast:8 row_mask:0xf bank_mask:0xf
    v_dot2c_f32_bf16_dpp v9, v25, v212 row_newbcast:8 row_mask:0xf bank_mask:0xf
    v_dot2c_f32_bf16_dpp v10, v24, v213 row_newbcast:8 row_mask:0xf bank_mask:0xf
    v_dot2c_f32_bf16_dpp v11, v25, v213 row_newbcast:8 row_mask:0xf bank_mask:0xf
    v_dot2c_f32_bf16_dpp v12, v24, v214 row_newbcast:8 row_mask:0xf bank_mask:0xf
    v_dot2c_f32_bf16_dpp v13, v25, v214 row_newbcast:8 row_mask:0xf bank_mask:0xf
    v_dot2c_f32_bf16_dpp v14, v24, v215 row_newbcast:8 row_mask:0xf bank_mask:0xf
    v_dot2c_f32_bf16_dpp v15, v25, v215 row_newbcast:8 row_mask:0xf bank_mask:0xf
    v_dot2c_f32_bf16_dpp v8, v24, v216 row_newbcast:4 row_mask:0xf bank_mask:0xf
    v_dot2c_f32_bf16_dpp v9, v25, v216 row_newbcast:4 row_mask:0xf bank_mask:0xf
    v_dot2c_f32_bf16_dpp v10, v24, v217 row_newbcast:4 row_mask:0xf bank_mask:0xf
    v_dot2c_f32_bf16_dpp v11, v25, v217 row_newbcast:4 row_mask:0xf bank_mask:0xf
    v_dot2c_f32_bf16_dpp v12, v24, v218 row_newbcast:4 row_mask:0xf bank_mask:0xf
    v_dot2c_f32_bf16_dpp v13, v25, v218 row_newbcast:4 row_mask:0xf bank_mask:0xf
    v_dot2c_f32_bf16_dpp v14, v24, v219 row_newbcast:4 row_mask:0xf bank_mask:0xf
    v_dot2c_f32_bf16_dpp v15, v25, v219 row_newbcast:4 row_mask:0xf bank_mask:0xf
    v_dot2c_f32_bf16_dpp v8, v24, v220 row_newbcast:12 row_mask:0xf bank_mask:0xf
    v_dot2c_f32_bf16_dpp v9, v25, v220 row_newbcast:12 row_mask:0xf bank_mask:0xf
    v_dot2c_f32_bf16_dpp v10, v24, v221 row_newbcast:12 row_mask:0xf bank_mask:0xf
    v_dot2c_f32_bf16_dpp v11, v25, v221 row_newbcast:12 row_mask:0xf bank_mask:0xf
    v_dot2c_f32_bf16_dpp v12, v24, v222 row_newbcast:12 row_mask:0xf bank_mask:0xf
    v_dot2c_f32_bf16_dpp v13, v25, v222 row_newbcast:12 row_mask:0xf bank_mask:0xf
    v_dot2c_f32_bf16_dpp v14, v24, v223 row_newbcast:12 row_mask:0xf bank_mask:0xf
    v_dot2c_f32_bf16_dpp v15, v25, v223 row_newbcast:12 row_mask:0xf bank_mask:0xf
    s_mov_b32 s46, 38400
    buffer_load_dwordx4 v[124:127], v32, s[20:23], s46 offen
    buffer_load_dwordx4 v[208:211], v1, s[8:11], s43 offen offset:0 sc0 sc1 nt
    buffer_load_dwordx4 v[212:215], v1, s[8:11], s43 offen offset:1024 sc0 sc1 nt
    buffer_load_dwordx4 v[216:219], v1, s[8:11], s43 offen offset:2048 sc0 sc1 nt
    buffer_load_dwordx4 v[220:223], v1, s[8:11], s43 offen offset:3072 sc0 sc1 nt
    v_dot2_f32_bf16 v20, v224, v16, 0
    v_dot2_f32_bf16 v21, v228, v16, 0
    v_dot2_f32_bf16 v22, v232, v16, 0
    v_dot2_f32_bf16 v23, v236, v16, 0
    v_dot2c_f32_bf16 v20, v225, v17
    v_dot2c_f32_bf16 v21, v229, v17
    v_dot2c_f32_bf16 v22, v233, v17
    v_dot2c_f32_bf16 v23, v237, v17
    v_dot2c_f32_bf16 v20, v226, v18
    v_dot2c_f32_bf16 v21, v230, v18
    v_dot2c_f32_bf16 v22, v234, v18
    v_dot2c_f32_bf16 v23, v238, v18
    v_dot2c_f32_bf16 v20, v227, v19
    v_dot2c_f32_bf16 v21, v231, v19
    v_dot2c_f32_bf16 v22, v235, v19
    v_dot2c_f32_bf16 v23, v239, v19
    s_mov_b32 s46, 46080
    buffer_load_dwordx4 v[128:131], v32, s[20:23], s46 offen
    s_add_u32 s43, s43, 32768
    buffer_load_dwordx4 v[224:227], v1, s[4:7], s43 offen offset:0 sc0 sc1 nt
    buffer_load_dwordx4 v[228:231], v1, s[4:7], s43 offen offset:1024 sc0 sc1 nt
    buffer_load_dwordx4 v[232:235], v1, s[4:7], s43 offen offset:2048 sc0 sc1 nt
    buffer_load_dwordx4 v[236:239], v1, s[4:7], s43 offen offset:3072 sc0 sc1 nt
    v_add_f32_dpp v20, v20, v20 row_ror:8 row_mask:0xf bank_mask:0x3
    v_add_f32_dpp v22, v22, v22 row_ror:8 row_mask:0xf bank_mask:0x3
    s_nop 0
    v_add_f32_dpp v20, v21, v21 row_ror:8 row_mask:0xf bank_mask:0xc
    v_add_f32_dpp v22, v23, v23 row_ror:8 row_mask:0xf bank_mask:0xc
    s_nop 0
    v_add_f32_dpp v20, v20, v20 row_half_mirror row_mask:0xf bank_mask:0x5
    s_nop 1
    v_add_f32_dpp v20, v22, v22 row_half_mirror row_mask:0xf bank_mask:0xa
    s_nop 1
    v_add_f32_dpp v20, v20, v20 quad_perm:[1,0,3,2] row_mask:0xf bank_mask:0xf
    s_nop 1
    v_add_f32_dpp v20, v20, v20 quad_perm:[2,3,0,1] row_mask:0xf bank_mask:0xf
    v_cvt_pk_bf16_f32 v20, v20, v20
    v_and_b32 v20, s50, v20
    v_mul_f32 v20, s51, v20
    v_cvt_pk_bf16_f32 v20, v20, v20
    v_and_b32 v20, s50, v20
    s_nop 1
    v_max_f32_dpp v21, v20, v20 row_ror:4 row_mask:0xf bank_mask:0xf
    s_nop 1
    v_max_f32_dpp v21, v21, v21 row_ror:8 row_mask:0xf bank_mask:0xf
    v_max_f32 v21, v21, v5
    v_sub_f32 v22, v5, v21
    v_sub_f32 v20, v20, v21
    v_mov_b32 v5, v21
    v_mul_f32 v22, s52, v22
    v_mul_f32 v20, s52, v20
    v_exp_f32 v26, v22
    v_exp_f32 v20, v20
    v_pk_mul_f32 v[8:9], v[8:9], v[26:27] op_sel_hi:[1,0]
    v_pk_mul_f32 v[10:11], v[10:11], v[26:27] op_sel_hi:[1,0]
    v_pk_mul_f32 v[12:13], v[12:13], v[26:27] op_sel_hi:[1,0]
    v_pk_mul_f32 v[14:15], v[14:15], v[26:27] op_sel_hi:[1,0]
    v_cvt_pk_bf16_f32 v24, v20, 0
    v_cvt_pk_bf16_f32 v25, 0, v20
    v_fma_f32 v6, v6, v26, v20
    s_waitcnt vmcnt(35)
    v_dot2c_f32_bf16_dpp v8, v24, v240 row_newbcast:0 row_mask:0xf bank_mask:0xf
    v_dot2c_f32_bf16_dpp v9, v25, v240 row_newbcast:0 row_mask:0xf bank_mask:0xf
    v_dot2c_f32_bf16_dpp v10, v24, v241 row_newbcast:0 row_mask:0xf bank_mask:0xf
    v_dot2c_f32_bf16_dpp v11, v25, v241 row_newbcast:0 row_mask:0xf bank_mask:0xf
    v_dot2c_f32_bf16_dpp v12, v24, v242 row_newbcast:0 row_mask:0xf bank_mask:0xf
    v_dot2c_f32_bf16_dpp v13, v25, v242 row_newbcast:0 row_mask:0xf bank_mask:0xf
    v_dot2c_f32_bf16_dpp v14, v24, v243 row_newbcast:0 row_mask:0xf bank_mask:0xf
    v_dot2c_f32_bf16_dpp v15, v25, v243 row_newbcast:0 row_mask:0xf bank_mask:0xf
    v_dot2c_f32_bf16_dpp v8, v24, v244 row_newbcast:8 row_mask:0xf bank_mask:0xf
    v_dot2c_f32_bf16_dpp v9, v25, v244 row_newbcast:8 row_mask:0xf bank_mask:0xf
    v_dot2c_f32_bf16_dpp v10, v24, v245 row_newbcast:8 row_mask:0xf bank_mask:0xf
    v_dot2c_f32_bf16_dpp v11, v25, v245 row_newbcast:8 row_mask:0xf bank_mask:0xf
    v_dot2c_f32_bf16_dpp v12, v24, v246 row_newbcast:8 row_mask:0xf bank_mask:0xf
    v_dot2c_f32_bf16_dpp v13, v25, v246 row_newbcast:8 row_mask:0xf bank_mask:0xf
    v_dot2c_f32_bf16_dpp v14, v24, v247 row_newbcast:8 row_mask:0xf bank_mask:0xf
    v_dot2c_f32_bf16_dpp v15, v25, v247 row_newbcast:8 row_mask:0xf bank_mask:0xf
    v_dot2c_f32_bf16_dpp v8, v24, v248 row_newbcast:4 row_mask:0xf bank_mask:0xf
    v_dot2c_f32_bf16_dpp v9, v25, v248 row_newbcast:4 row_mask:0xf bank_mask:0xf
    v_dot2c_f32_bf16_dpp v10, v24, v249 row_newbcast:4 row_mask:0xf bank_mask:0xf
    v_dot2c_f32_bf16_dpp v11, v25, v249 row_newbcast:4 row_mask:0xf bank_mask:0xf
    v_dot2c_f32_bf16_dpp v12, v24, v250 row_newbcast:4 row_mask:0xf bank_mask:0xf
    v_dot2c_f32_bf16_dpp v13, v25, v250 row_newbcast:4 row_mask:0xf bank_mask:0xf
    v_dot2c_f32_bf16_dpp v14, v24, v251 row_newbcast:4 row_mask:0xf bank_mask:0xf
    v_dot2c_f32_bf16_dpp v15, v25, v251 row_newbcast:4 row_mask:0xf bank_mask:0xf
    v_dot2c_f32_bf16_dpp v8, v24, v252 row_newbcast:12 row_mask:0xf bank_mask:0xf
    v_dot2c_f32_bf16_dpp v9, v25, v252 row_newbcast:12 row_mask:0xf bank_mask:0xf
    v_dot2c_f32_bf16_dpp v10, v24, v253 row_newbcast:12 row_mask:0xf bank_mask:0xf
    v_dot2c_f32_bf16_dpp v11, v25, v253 row_newbcast:12 row_mask:0xf bank_mask:0xf
    v_dot2c_f32_bf16_dpp v12, v24, v254 row_newbcast:12 row_mask:0xf bank_mask:0xf
    v_dot2c_f32_bf16_dpp v13, v25, v254 row_newbcast:12 row_mask:0xf bank_mask:0xf
    v_dot2c_f32_bf16_dpp v14, v24, v255 row_newbcast:12 row_mask:0xf bank_mask:0xf
    v_dot2c_f32_bf16_dpp v15, v25, v255 row_newbcast:12 row_mask:0xf bank_mask:0xf
    s_mov_b32 s46, 53760
    buffer_load_dwordx4 v[132:135], v32, s[20:23], s46 offen
    buffer_load_dwordx4 v[240:243], v1, s[8:11], s43 offen offset:0 sc0 sc1 nt
    buffer_load_dwordx4 v[244:247], v1, s[8:11], s43 offen offset:1024 sc0 sc1 nt
    buffer_load_dwordx4 v[248:251], v1, s[8:11], s43 offen offset:2048 sc0 sc1 nt
    buffer_load_dwordx4 v[252:255], v1, s[8:11], s43 offen offset:3072 sc0 sc1 nt
    s_waitcnt vmcnt(35)
    v_dot2_f32_bf16 v20, v40, v16, 0
    v_dot2_f32_bf16 v21, v44, v16, 0
    v_dot2_f32_bf16 v22, v48, v16, 0
    v_dot2_f32_bf16 v23, v52, v16, 0
    v_dot2c_f32_bf16 v20, v41, v17
    v_dot2c_f32_bf16 v21, v45, v17
    v_dot2c_f32_bf16 v22, v49, v17
    v_dot2c_f32_bf16 v23, v53, v17
    v_dot2c_f32_bf16 v20, v42, v18
    v_dot2c_f32_bf16 v21, v46, v18
    v_dot2c_f32_bf16 v22, v50, v18
    v_dot2c_f32_bf16 v23, v54, v18
    v_dot2c_f32_bf16 v20, v43, v19
    v_dot2c_f32_bf16 v21, v47, v19
    v_dot2c_f32_bf16 v22, v51, v19
    v_dot2c_f32_bf16 v23, v55, v19
    s_mov_b32 s46, 61440
    buffer_load_dwordx4 v[136:139], v32, s[20:23], s46 offen
    s_add_u32 s43, s43, 32768
    buffer_load_dwordx4 v[40:43], v1, s[4:7], s43 offen offset:0 sc0 sc1 nt
    buffer_load_dwordx4 v[44:47], v1, s[4:7], s43 offen offset:1024 sc0 sc1 nt
    buffer_load_dwordx4 v[48:51], v1, s[4:7], s43 offen offset:2048 sc0 sc1 nt
    buffer_load_dwordx4 v[52:55], v1, s[4:7], s43 offen offset:3072 sc0 sc1 nt
    v_add_f32_dpp v20, v20, v20 row_ror:8 row_mask:0xf bank_mask:0x3
    v_add_f32_dpp v22, v22, v22 row_ror:8 row_mask:0xf bank_mask:0x3
    s_nop 0
    v_add_f32_dpp v20, v21, v21 row_ror:8 row_mask:0xf bank_mask:0xc
    v_add_f32_dpp v22, v23, v23 row_ror:8 row_mask:0xf bank_mask:0xc
    s_nop 0
    v_add_f32_dpp v20, v20, v20 row_half_mirror row_mask:0xf bank_mask:0x5
    s_nop 1
    v_add_f32_dpp v20, v22, v22 row_half_mirror row_mask:0xf bank_mask:0xa
    s_nop 1
    v_add_f32_dpp v20, v20, v20 quad_perm:[1,0,3,2] row_mask:0xf bank_mask:0xf
    s_nop 1
    v_add_f32_dpp v20, v20, v20 quad_perm:[2,3,0,1] row_mask:0xf bank_mask:0xf
    v_cvt_pk_bf16_f32 v20, v20, v20
    v_and_b32 v20, s50, v20
    v_mul_f32 v20, s51, v20
    v_cvt_pk_bf16_f32 v20, v20, v20
    v_and_b32 v20, s50, v20
    s_nop 1
    v_max_f32_dpp v21, v20, v20 row_ror:4 row_mask:0xf bank_mask:0xf
    s_nop 1
    v_max_f32_dpp v21, v21, v21 row_ror:8 row_mask:0xf bank_mask:0xf
    v_max_f32 v21, v21, v5
    v_sub_f32 v22, v5, v21
    v_sub_f32 v20, v20, v21
    v_mov_b32 v5, v21
    v_mul_f32 v22, s52, v22
    v_mul_f32 v20, s52, v20
    v_exp_f32 v26, v22
    v_exp_f32 v20, v20
    v_pk_mul_f32 v[8:9], v[8:9], v[26:27] op_sel_hi:[1,0]
    v_pk_mul_f32 v[10:11], v[10:11], v[26:27] op_sel_hi:[1,0]
    v_pk_mul_f32 v[12:13], v[12:13], v[26:27] op_sel_hi:[1,0]
    v_pk_mul_f32 v[14:15], v[14:15], v[26:27] op_sel_hi:[1,0]
    v_cvt_pk_bf16_f32 v24, v20, 0
    v_cvt_pk_bf16_f32 v25, 0, v20
    v_fma_f32 v6, v6, v26, v20
    s_waitcnt vmcnt(35)
    v_dot2c_f32_bf16_dpp v8, v24, v56 row_newbcast:0 row_mask:0xf bank_mask:0xf
    v_dot2c_f32_bf16_dpp v9, v25, v56 row_newbcast:0 row_mask:0xf bank_mask:0xf
    v_dot2c_f32_bf16_dpp v10, v24, v57 row_newbcast:0 row_mask:0xf bank_mask:0xf
    v_dot2c_f32_bf16_dpp v11, v25, v57 row_newbcast:0 row_mask:0xf bank_mask:0xf
    v_dot2c_f32_bf16_dpp v12, v24, v58 row_newbcast:0 row_mask:0xf bank_mask:0xf
    v_dot2c_f32_bf16_dpp v13, v25, v58 row_newbcast:0 row_mask:0xf bank_mask:0xf
    v_dot2c_f32_bf16_dpp v14, v24, v59 row_newbcast:0 row_mask:0xf bank_mask:0xf
    v_dot2c_f32_bf16_dpp v15, v25, v59 row_newbcast:0 row_mask:0xf bank_mask:0xf
    v_dot2c_f32_bf16_dpp v8, v24, v60 row_newbcast:8 row_mask:0xf bank_mask:0xf
    v_dot2c_f32_bf16_dpp v9, v25, v60 row_newbcast:8 row_mask:0xf bank_mask:0xf
    v_dot2c_f32_bf16_dpp v10, v24, v61 row_newbcast:8 row_mask:0xf bank_mask:0xf
    v_dot2c_f32_bf16_dpp v11, v25, v61 row_newbcast:8 row_mask:0xf bank_mask:0xf
    v_dot2c_f32_bf16_dpp v12, v24, v62 row_newbcast:8 row_mask:0xf bank_mask:0xf
    v_dot2c_f32_bf16_dpp v13, v25, v62 row_newbcast:8 row_mask:0xf bank_mask:0xf
    v_dot2c_f32_bf16_dpp v14, v24, v63 row_newbcast:8 row_mask:0xf bank_mask:0xf
    v_dot2c_f32_bf16_dpp v15, v25, v63 row_newbcast:8 row_mask:0xf bank_mask:0xf
    v_dot2c_f32_bf16_dpp v8, v24, v64 row_newbcast:4 row_mask:0xf bank_mask:0xf
    v_dot2c_f32_bf16_dpp v9, v25, v64 row_newbcast:4 row_mask:0xf bank_mask:0xf
    v_dot2c_f32_bf16_dpp v10, v24, v65 row_newbcast:4 row_mask:0xf bank_mask:0xf
    v_dot2c_f32_bf16_dpp v11, v25, v65 row_newbcast:4 row_mask:0xf bank_mask:0xf
    v_dot2c_f32_bf16_dpp v12, v24, v66 row_newbcast:4 row_mask:0xf bank_mask:0xf
    v_dot2c_f32_bf16_dpp v13, v25, v66 row_newbcast:4 row_mask:0xf bank_mask:0xf
    v_dot2c_f32_bf16_dpp v14, v24, v67 row_newbcast:4 row_mask:0xf bank_mask:0xf
    v_dot2c_f32_bf16_dpp v15, v25, v67 row_newbcast:4 row_mask:0xf bank_mask:0xf
    v_dot2c_f32_bf16_dpp v8, v24, v68 row_newbcast:12 row_mask:0xf bank_mask:0xf
    v_dot2c_f32_bf16_dpp v9, v25, v68 row_newbcast:12 row_mask:0xf bank_mask:0xf
    v_dot2c_f32_bf16_dpp v10, v24, v69 row_newbcast:12 row_mask:0xf bank_mask:0xf
    v_dot2c_f32_bf16_dpp v11, v25, v69 row_newbcast:12 row_mask:0xf bank_mask:0xf
    v_dot2c_f32_bf16_dpp v12, v24, v70 row_newbcast:12 row_mask:0xf bank_mask:0xf
    v_dot2c_f32_bf16_dpp v13, v25, v70 row_newbcast:12 row_mask:0xf bank_mask:0xf
    v_dot2c_f32_bf16_dpp v14, v24, v71 row_newbcast:12 row_mask:0xf bank_mask:0xf
    v_dot2c_f32_bf16_dpp v15, v25, v71 row_newbcast:12 row_mask:0xf bank_mask:0xf
    s_mov_b32 s46, 69120
    buffer_load_dwordx4 v[140:143], v32, s[20:23], s46 offen
    buffer_load_dwordx4 v[56:59], v1, s[8:11], s43 offen offset:0 sc0 sc1 nt
    buffer_load_dwordx4 v[60:63], v1, s[8:11], s43 offen offset:1024 sc0 sc1 nt
    buffer_load_dwordx4 v[64:67], v1, s[8:11], s43 offen offset:2048 sc0 sc1 nt
    buffer_load_dwordx4 v[68:71], v1, s[8:11], s43 offen offset:3072 sc0 sc1 nt
    s_waitcnt vmcnt(35)
    v_dot2_f32_bf16 v20, v72, v16, 0
    v_dot2_f32_bf16 v21, v76, v16, 0
    v_dot2_f32_bf16 v22, v80, v16, 0
    v_dot2_f32_bf16 v23, v84, v16, 0
    v_dot2c_f32_bf16 v20, v73, v17
    v_dot2c_f32_bf16 v21, v77, v17
    v_dot2c_f32_bf16 v22, v81, v17
    v_dot2c_f32_bf16 v23, v85, v17
    v_dot2c_f32_bf16 v20, v74, v18
    v_dot2c_f32_bf16 v21, v78, v18
    v_dot2c_f32_bf16 v22, v82, v18
    v_dot2c_f32_bf16 v23, v86, v18
    v_dot2c_f32_bf16 v20, v75, v19
    v_dot2c_f32_bf16 v21, v79, v19
    v_dot2c_f32_bf16 v22, v83, v19
    v_dot2c_f32_bf16 v23, v87, v19
    s_mov_b32 s46, 76800
    buffer_load_dwordx4 v[144:147], v32, s[20:23], s46 offen
    s_add_u32 s43, s43, 32768
    buffer_load_dwordx4 v[72:75], v1, s[4:7], s43 offen offset:0 sc0 sc1 nt
    buffer_load_dwordx4 v[76:79], v1, s[4:7], s43 offen offset:1024 sc0 sc1 nt
    buffer_load_dwordx4 v[80:83], v1, s[4:7], s43 offen offset:2048 sc0 sc1 nt
    buffer_load_dwordx4 v[84:87], v1, s[4:7], s43 offen offset:3072 sc0 sc1 nt
    v_add_f32_dpp v20, v20, v20 row_ror:8 row_mask:0xf bank_mask:0x3
    v_add_f32_dpp v22, v22, v22 row_ror:8 row_mask:0xf bank_mask:0x3
    s_nop 0
    v_add_f32_dpp v20, v21, v21 row_ror:8 row_mask:0xf bank_mask:0xc
    v_add_f32_dpp v22, v23, v23 row_ror:8 row_mask:0xf bank_mask:0xc
    s_nop 0
    v_add_f32_dpp v20, v20, v20 row_half_mirror row_mask:0xf bank_mask:0x5
    s_nop 1
    v_add_f32_dpp v20, v22, v22 row_half_mirror row_mask:0xf bank_mask:0xa
    s_nop 1
    v_add_f32_dpp v20, v20, v20 quad_perm:[1,0,3,2] row_mask:0xf bank_mask:0xf
    s_nop 1
    v_add_f32_dpp v20, v20, v20 quad_perm:[2,3,0,1] row_mask:0xf bank_mask:0xf
    v_cvt_pk_bf16_f32 v20, v20, v20
    v_and_b32 v20, s50, v20
    v_mul_f32 v20, s51, v20
    v_cvt_pk_bf16_f32 v20, v20, v20
    v_and_b32 v20, s50, v20
    s_nop 1
    v_max_f32_dpp v21, v20, v20 row_ror:4 row_mask:0xf bank_mask:0xf
    s_nop 1
    v_max_f32_dpp v21, v21, v21 row_ror:8 row_mask:0xf bank_mask:0xf
    v_max_f32 v21, v21, v5
    v_sub_f32 v22, v5, v21
    v_sub_f32 v20, v20, v21
    v_mov_b32 v5, v21
    v_mul_f32 v22, s52, v22
    v_mul_f32 v20, s52, v20
    v_exp_f32 v26, v22
    v_exp_f32 v20, v20
    v_pk_mul_f32 v[8:9], v[8:9], v[26:27] op_sel_hi:[1,0]
    v_pk_mul_f32 v[10:11], v[10:11], v[26:27] op_sel_hi:[1,0]
    v_pk_mul_f32 v[12:13], v[12:13], v[26:27] op_sel_hi:[1,0]
    v_pk_mul_f32 v[14:15], v[14:15], v[26:27] op_sel_hi:[1,0]
    v_cvt_pk_bf16_f32 v24, v20, 0
    v_cvt_pk_bf16_f32 v25, 0, v20
    v_fma_f32 v6, v6, v26, v20
    s_waitcnt vmcnt(35)
    v_dot2c_f32_bf16_dpp v8, v24, v88 row_newbcast:0 row_mask:0xf bank_mask:0xf
    v_dot2c_f32_bf16_dpp v9, v25, v88 row_newbcast:0 row_mask:0xf bank_mask:0xf
    v_dot2c_f32_bf16_dpp v10, v24, v89 row_newbcast:0 row_mask:0xf bank_mask:0xf
    v_dot2c_f32_bf16_dpp v11, v25, v89 row_newbcast:0 row_mask:0xf bank_mask:0xf
    v_dot2c_f32_bf16_dpp v12, v24, v90 row_newbcast:0 row_mask:0xf bank_mask:0xf
    v_dot2c_f32_bf16_dpp v13, v25, v90 row_newbcast:0 row_mask:0xf bank_mask:0xf
    v_dot2c_f32_bf16_dpp v14, v24, v91 row_newbcast:0 row_mask:0xf bank_mask:0xf
    v_dot2c_f32_bf16_dpp v15, v25, v91 row_newbcast:0 row_mask:0xf bank_mask:0xf
    v_dot2c_f32_bf16_dpp v8, v24, v92 row_newbcast:8 row_mask:0xf bank_mask:0xf
    v_dot2c_f32_bf16_dpp v9, v25, v92 row_newbcast:8 row_mask:0xf bank_mask:0xf
    v_dot2c_f32_bf16_dpp v10, v24, v93 row_newbcast:8 row_mask:0xf bank_mask:0xf
    v_dot2c_f32_bf16_dpp v11, v25, v93 row_newbcast:8 row_mask:0xf bank_mask:0xf
    v_dot2c_f32_bf16_dpp v12, v24, v94 row_newbcast:8 row_mask:0xf bank_mask:0xf
    v_dot2c_f32_bf16_dpp v13, v25, v94 row_newbcast:8 row_mask:0xf bank_mask:0xf
    v_dot2c_f32_bf16_dpp v14, v24, v95 row_newbcast:8 row_mask:0xf bank_mask:0xf
    v_dot2c_f32_bf16_dpp v15, v25, v95 row_newbcast:8 row_mask:0xf bank_mask:0xf
    v_dot2c_f32_bf16_dpp v8, v24, v96 row_newbcast:4 row_mask:0xf bank_mask:0xf
    v_dot2c_f32_bf16_dpp v9, v25, v96 row_newbcast:4 row_mask:0xf bank_mask:0xf
    v_dot2c_f32_bf16_dpp v10, v24, v97 row_newbcast:4 row_mask:0xf bank_mask:0xf
    v_dot2c_f32_bf16_dpp v11, v25, v97 row_newbcast:4 row_mask:0xf bank_mask:0xf
    v_dot2c_f32_bf16_dpp v12, v24, v98 row_newbcast:4 row_mask:0xf bank_mask:0xf
    v_dot2c_f32_bf16_dpp v13, v25, v98 row_newbcast:4 row_mask:0xf bank_mask:0xf
    v_dot2c_f32_bf16_dpp v14, v24, v99 row_newbcast:4 row_mask:0xf bank_mask:0xf
    v_dot2c_f32_bf16_dpp v15, v25, v99 row_newbcast:4 row_mask:0xf bank_mask:0xf
    v_dot2c_f32_bf16_dpp v8, v24, v100 row_newbcast:12 row_mask:0xf bank_mask:0xf
    v_dot2c_f32_bf16_dpp v9, v25, v100 row_newbcast:12 row_mask:0xf bank_mask:0xf
    v_dot2c_f32_bf16_dpp v10, v24, v101 row_newbcast:12 row_mask:0xf bank_mask:0xf
    v_dot2c_f32_bf16_dpp v11, v25, v101 row_newbcast:12 row_mask:0xf bank_mask:0xf
    v_dot2c_f32_bf16_dpp v12, v24, v102 row_newbcast:12 row_mask:0xf bank_mask:0xf
    v_dot2c_f32_bf16_dpp v13, v25, v102 row_newbcast:12 row_mask:0xf bank_mask:0xf
    v_dot2c_f32_bf16_dpp v14, v24, v103 row_newbcast:12 row_mask:0xf bank_mask:0xf
    v_dot2c_f32_bf16_dpp v15, v25, v103 row_newbcast:12 row_mask:0xf bank_mask:0xf
    s_mov_b32 s46, 84480
    buffer_load_dwordx4 v[148:151], v32, s[20:23], s46 offen
    buffer_load_dwordx4 v[88:91], v1, s[8:11], s43 offen offset:0 sc0 sc1 nt
    buffer_load_dwordx4 v[92:95], v1, s[8:11], s43 offen offset:1024 sc0 sc1 nt
    buffer_load_dwordx4 v[96:99], v1, s[8:11], s43 offen offset:2048 sc0 sc1 nt
    buffer_load_dwordx4 v[100:103], v1, s[8:11], s43 offen offset:3072 sc0 sc1 nt
    s_waitcnt vmcnt(35)
    v_dot2_f32_bf16 v20, v192, v16, 0
    v_dot2_f32_bf16 v21, v196, v16, 0
    v_dot2_f32_bf16 v22, v200, v16, 0
    v_dot2_f32_bf16 v23, v204, v16, 0
    v_dot2c_f32_bf16 v20, v193, v17
    v_dot2c_f32_bf16 v21, v197, v17
    v_dot2c_f32_bf16 v22, v201, v17
    v_dot2c_f32_bf16 v23, v205, v17
    v_dot2c_f32_bf16 v20, v194, v18
    v_dot2c_f32_bf16 v21, v198, v18
    v_dot2c_f32_bf16 v22, v202, v18
    v_dot2c_f32_bf16 v23, v206, v18
    v_dot2c_f32_bf16 v20, v195, v19
    v_dot2c_f32_bf16 v21, v199, v19
    v_dot2c_f32_bf16 v22, v203, v19
    v_dot2c_f32_bf16 v23, v207, v19
    s_mov_b32 s46, 92160
    buffer_load_dwordx4 v[152:155], v32, s[20:23], s46 offen
    s_add_u32 s43, s43, 32768
    buffer_load_dwordx4 v[192:195], v1, s[4:7], s43 offen offset:0 sc0 sc1 nt
    buffer_load_dwordx4 v[196:199], v1, s[4:7], s43 offen offset:1024 sc0 sc1 nt
    buffer_load_dwordx4 v[200:203], v1, s[4:7], s43 offen offset:2048 sc0 sc1 nt
    buffer_load_dwordx4 v[204:207], v1, s[4:7], s43 offen offset:3072 sc0 sc1 nt
    v_add_f32_dpp v20, v20, v20 row_ror:8 row_mask:0xf bank_mask:0x3
    v_add_f32_dpp v22, v22, v22 row_ror:8 row_mask:0xf bank_mask:0x3
    s_nop 0
    v_add_f32_dpp v20, v21, v21 row_ror:8 row_mask:0xf bank_mask:0xc
    v_add_f32_dpp v22, v23, v23 row_ror:8 row_mask:0xf bank_mask:0xc
    s_nop 0
    v_add_f32_dpp v20, v20, v20 row_half_mirror row_mask:0xf bank_mask:0x5
    s_nop 1
    v_add_f32_dpp v20, v22, v22 row_half_mirror row_mask:0xf bank_mask:0xa
    s_nop 1
    v_add_f32_dpp v20, v20, v20 quad_perm:[1,0,3,2] row_mask:0xf bank_mask:0xf
    s_nop 1
    v_add_f32_dpp v20, v20, v20 quad_perm:[2,3,0,1] row_mask:0xf bank_mask:0xf
    v_cvt_pk_bf16_f32 v20, v20, v20
    v_and_b32 v20, s50, v20
    v_mul_f32 v20, s51, v20
    v_cvt_pk_bf16_f32 v20, v20, v20
    v_and_b32 v20, s50, v20
    s_nop 1
    v_max_f32_dpp v21, v20, v20 row_ror:4 row_mask:0xf bank_mask:0xf
    s_nop 1
    v_max_f32_dpp v21, v21, v21 row_ror:8 row_mask:0xf bank_mask:0xf
    v_max_f32 v21, v21, v5
    v_sub_f32 v22, v5, v21
    v_sub_f32 v20, v20, v21
    v_mov_b32 v5, v21
    v_mul_f32 v22, s52, v22
    v_mul_f32 v20, s52, v20
    v_exp_f32 v26, v22
    v_exp_f32 v20, v20
    v_pk_mul_f32 v[8:9], v[8:9], v[26:27] op_sel_hi:[1,0]
    v_pk_mul_f32 v[10:11], v[10:11], v[26:27] op_sel_hi:[1,0]
    v_pk_mul_f32 v[12:13], v[12:13], v[26:27] op_sel_hi:[1,0]
    v_pk_mul_f32 v[14:15], v[14:15], v[26:27] op_sel_hi:[1,0]
    v_cvt_pk_bf16_f32 v24, v20, 0
    v_cvt_pk_bf16_f32 v25, 0, v20
    v_fma_f32 v6, v6, v26, v20
    s_waitcnt vmcnt(35)
    v_dot2c_f32_bf16_dpp v8, v24, v208 row_newbcast:0 row_mask:0xf bank_mask:0xf
    v_dot2c_f32_bf16_dpp v9, v25, v208 row_newbcast:0 row_mask:0xf bank_mask:0xf
    v_dot2c_f32_bf16_dpp v10, v24, v209 row_newbcast:0 row_mask:0xf bank_mask:0xf
    v_dot2c_f32_bf16_dpp v11, v25, v209 row_newbcast:0 row_mask:0xf bank_mask:0xf
    v_dot2c_f32_bf16_dpp v12, v24, v210 row_newbcast:0 row_mask:0xf bank_mask:0xf
    v_dot2c_f32_bf16_dpp v13, v25, v210 row_newbcast:0 row_mask:0xf bank_mask:0xf
    v_dot2c_f32_bf16_dpp v14, v24, v211 row_newbcast:0 row_mask:0xf bank_mask:0xf
    v_dot2c_f32_bf16_dpp v15, v25, v211 row_newbcast:0 row_mask:0xf bank_mask:0xf
    v_dot2c_f32_bf16_dpp v8, v24, v212 row_newbcast:8 row_mask:0xf bank_mask:0xf
    v_dot2c_f32_bf16_dpp v9, v25, v212 row_newbcast:8 row_mask:0xf bank_mask:0xf
    v_dot2c_f32_bf16_dpp v10, v24, v213 row_newbcast:8 row_mask:0xf bank_mask:0xf
    v_dot2c_f32_bf16_dpp v11, v25, v213 row_newbcast:8 row_mask:0xf bank_mask:0xf
    v_dot2c_f32_bf16_dpp v12, v24, v214 row_newbcast:8 row_mask:0xf bank_mask:0xf
    v_dot2c_f32_bf16_dpp v13, v25, v214 row_newbcast:8 row_mask:0xf bank_mask:0xf
    v_dot2c_f32_bf16_dpp v14, v24, v215 row_newbcast:8 row_mask:0xf bank_mask:0xf
    v_dot2c_f32_bf16_dpp v15, v25, v215 row_newbcast:8 row_mask:0xf bank_mask:0xf
    v_dot2c_f32_bf16_dpp v8, v24, v216 row_newbcast:4 row_mask:0xf bank_mask:0xf
    v_dot2c_f32_bf16_dpp v9, v25, v216 row_newbcast:4 row_mask:0xf bank_mask:0xf
    v_dot2c_f32_bf16_dpp v10, v24, v217 row_newbcast:4 row_mask:0xf bank_mask:0xf
    v_dot2c_f32_bf16_dpp v11, v25, v217 row_newbcast:4 row_mask:0xf bank_mask:0xf
    v_dot2c_f32_bf16_dpp v12, v24, v218 row_newbcast:4 row_mask:0xf bank_mask:0xf
    v_dot2c_f32_bf16_dpp v13, v25, v218 row_newbcast:4 row_mask:0xf bank_mask:0xf
    v_dot2c_f32_bf16_dpp v14, v24, v219 row_newbcast:4 row_mask:0xf bank_mask:0xf
    v_dot2c_f32_bf16_dpp v15, v25, v219 row_newbcast:4 row_mask:0xf bank_mask:0xf
    v_dot2c_f32_bf16_dpp v8, v24, v220 row_newbcast:12 row_mask:0xf bank_mask:0xf
    v_dot2c_f32_bf16_dpp v9, v25, v220 row_newbcast:12 row_mask:0xf bank_mask:0xf
    v_dot2c_f32_bf16_dpp v10, v24, v221 row_newbcast:12 row_mask:0xf bank_mask:0xf
    v_dot2c_f32_bf16_dpp v11, v25, v221 row_newbcast:12 row_mask:0xf bank_mask:0xf
    v_dot2c_f32_bf16_dpp v12, v24, v222 row_newbcast:12 row_mask:0xf bank_mask:0xf
    v_dot2c_f32_bf16_dpp v13, v25, v222 row_newbcast:12 row_mask:0xf bank_mask:0xf
    v_dot2c_f32_bf16_dpp v14, v24, v223 row_newbcast:12 row_mask:0xf bank_mask:0xf
    v_dot2c_f32_bf16_dpp v15, v25, v223 row_newbcast:12 row_mask:0xf bank_mask:0xf
    s_cmp_lg_u32 s40, 0
    s_cbranch_scc1 L_nochk1
    v_lshlrev_b32 v7, 2, v1
    v_and_b32 v7, 0xc0, v7
    global_load_dword v28, v7, s[84:85] sc1
L_nochk1:
    s_mov_b32 s46, 99840
    buffer_load_dwordx4 v[156:159], v32, s[20:23], s46 offen
    buffer_load_dwordx4 v[208:211], v1, s[8:11], s43 offen offset:0 sc0 sc1 nt
    buffer_load_dwordx4 v[212:215], v1, s[8:11], s43 offen offset:1024 sc0 sc1 nt
    buffer_load_dwordx4 v[216:219], v1, s[8:11], s43 offen offset:2048 sc0 sc1 nt
    buffer_load_dwordx4 v[220:223], v1, s[8:11], s43 offen offset:3072 sc0 sc1 nt
    s_waitcnt vmcnt(35)
    v_dot2_f32_bf16 v20, v224, v16, 0
    v_dot2_f32_bf16 v21, v228, v16, 0
    v_dot2_f32_bf16 v22, v232, v16, 0
    v_dot2_f32_bf16 v23, v236, v16, 0
    v_dot2c_f32_bf16 v20, v225, v17
    v_dot2c_f32_bf16 v21, v229, v17
    v_dot2c_f32_bf16 v22, v233, v17
    v_dot2c_f32_bf16 v23, v237, v17
    v_dot2c_f32_bf16 v20, v226, v18
    v_dot2c_f32_bf16 v21, v230, v18
    v_dot2c_f32_bf16 v22, v234, v18
    v_dot2c_f32_bf16 v23, v238, v18
    v_dot2c_f32_bf16 v20, v227, v19
    v_dot2c_f32_bf16 v21, v231, v19
    v_dot2c_f32_bf16 v22, v235, v19
    v_dot2c_f32_bf16 v23, v239, v19
    s_mov_b32 s46, 107520
    buffer_load_dwordx4 v[160:163], v32, s[20:23], s46 offen
    s_add_u32 s43, s43, 32768
    buffer_load_dwordx4 v[224:227], v1, s[4:7], s43 offen offset:0 sc0 sc1 nt
    buffer_load_dwordx4 v[228:231], v1, s[4:7], s43 offen offset:1024 sc0 sc1 nt
    buffer_load_dwordx4 v[232:235], v1, s[4:7], s43 offen offset:2048 sc0 sc1 nt
    buffer_load_dwordx4 v[236:239], v1, s[4:7], s43 offen offset:3072 sc0 sc1 nt
    v_add_f32_dpp v20, v20, v20 row_ror:8 row_mask:0xf bank_mask:0x3
    v_add_f32_dpp v22, v22, v22 row_ror:8 row_mask:0xf bank_mask:0x3
    s_nop 0
    v_add_f32_dpp v20, v21, v21 row_ror:8 row_mask:0xf bank_mask:0xc
    v_add_f32_dpp v22, v23, v23 row_ror:8 row_mask:0xf bank_mask:0xc
    s_nop 0
    v_add_f32_dpp v20, v20, v20 row_half_mirror row_mask:0xf bank_mask:0x5
    s_nop 1
    v_add_f32_dpp v20, v22, v22 row_half_mirror row_mask:0xf bank_mask:0xa
    s_nop 1
    v_add_f32_dpp v20, v20, v20 quad_perm:[1,0,3,2] row_mask:0xf bank_mask:0xf
    s_nop 1
    v_add_f32_dpp v20, v20, v20 quad_perm:[2,3,0,1] row_mask:0xf bank_mask:0xf
    v_cvt_pk_bf16_f32 v20, v20, v20
    v_and_b32 v20, s50, v20
    v_mul_f32 v20, s51, v20
    v_cvt_pk_bf16_f32 v20, v20, v20
    v_and_b32 v20, s50, v20
    s_nop 1
    v_max_f32_dpp v21, v20, v20 row_ror:4 row_mask:0xf bank_mask:0xf
    s_nop 1
    v_max_f32_dpp v21, v21, v21 row_ror:8 row_mask:0xf bank_mask:0xf
    v_max_f32 v21, v21, v5
    v_sub_f32 v22, v5, v21
    v_sub_f32 v20, v20, v21
    v_mov_b32 v5, v21
    v_mul_f32 v22, s52, v22
    v_mul_f32 v20, s52, v20
    v_exp_f32 v26, v22
    v_exp_f32 v20, v20
    v_pk_mul_f32 v[8:9], v[8:9], v[26:27] op_sel_hi:[1,0]
    v_pk_mul_f32 v[10:11], v[10:11], v[26:27] op_sel_hi:[1,0]
    v_pk_mul_f32 v[12:13], v[12:13], v[26:27] op_sel_hi:[1,0]
    v_pk_mul_f32 v[14:15], v[14:15], v[26:27] op_sel_hi:[1,0]
    v_cvt_pk_bf16_f32 v24, v20, 0
    v_cvt_pk_bf16_f32 v25, 0, v20
    v_fma_f32 v6, v6, v26, v20
    s_waitcnt vmcnt(35)
    v_dot2c_f32_bf16_dpp v8, v24, v240 row_newbcast:0 row_mask:0xf bank_mask:0xf
    v_dot2c_f32_bf16_dpp v9, v25, v240 row_newbcast:0 row_mask:0xf bank_mask:0xf
    v_dot2c_f32_bf16_dpp v10, v24, v241 row_newbcast:0 row_mask:0xf bank_mask:0xf
    v_dot2c_f32_bf16_dpp v11, v25, v241 row_newbcast:0 row_mask:0xf bank_mask:0xf
    v_dot2c_f32_bf16_dpp v12, v24, v242 row_newbcast:0 row_mask:0xf bank_mask:0xf
    v_dot2c_f32_bf16_dpp v13, v25, v242 row_newbcast:0 row_mask:0xf bank_mask:0xf
    v_dot2c_f32_bf16_dpp v14, v24, v243 row_newbcast:0 row_mask:0xf bank_mask:0xf
    v_dot2c_f32_bf16_dpp v15, v25, v243 row_newbcast:0 row_mask:0xf bank_mask:0xf
    v_dot2c_f32_bf16_dpp v8, v24, v244 row_newbcast:8 row_mask:0xf bank_mask:0xf
    v_dot2c_f32_bf16_dpp v9, v25, v244 row_newbcast:8 row_mask:0xf bank_mask:0xf
    v_dot2c_f32_bf16_dpp v10, v24, v245 row_newbcast:8 row_mask:0xf bank_mask:0xf
    v_dot2c_f32_bf16_dpp v11, v25, v245 row_newbcast:8 row_mask:0xf bank_mask:0xf
    v_dot2c_f32_bf16_dpp v12, v24, v246 row_newbcast:8 row_mask:0xf bank_mask:0xf
    v_dot2c_f32_bf16_dpp v13, v25, v246 row_newbcast:8 row_mask:0xf bank_mask:0xf
    v_dot2c_f32_bf16_dpp v14, v24, v247 row_newbcast:8 row_mask:0xf bank_mask:0xf
    v_dot2c_f32_bf16_dpp v15, v25, v247 row_newbcast:8 row_mask:0xf bank_mask:0xf
    v_dot2c_f32_bf16_dpp v8, v24, v248 row_newbcast:4 row_mask:0xf bank_mask:0xf
    v_dot2c_f32_bf16_dpp v9, v25, v248 row_newbcast:4 row_mask:0xf bank_mask:0xf
    v_dot2c_f32_bf16_dpp v10, v24, v249 row_newbcast:4 row_mask:0xf bank_mask:0xf
    v_dot2c_f32_bf16_dpp v11, v25, v249 row_newbcast:4 row_mask:0xf bank_mask:0xf
    v_dot2c_f32_bf16_dpp v12, v24, v250 row_newbcast:4 row_mask:0xf bank_mask:0xf
    v_dot2c_f32_bf16_dpp v13, v25, v250 row_newbcast:4 row_mask:0xf bank_mask:0xf
    v_dot2c_f32_bf16_dpp v14, v24, v251 row_newbcast:4 row_mask:0xf bank_mask:0xf
    v_dot2c_f32_bf16_dpp v15, v25, v251 row_newbcast:4 row_mask:0xf bank_mask:0xf
    v_dot2c_f32_bf16_dpp v8, v24, v252 row_newbcast:12 row_mask:0xf bank_mask:0xf
    v_dot2c_f32_bf16_dpp v9, v25, v252 row_newbcast:12 row_mask:0xf bank_mask:0xf
    v_dot2c_f32_bf16_dpp v10, v24, v253 row_newbcast:12 row_mask:0xf bank_mask:0xf
    v_dot2c_f32_bf16_dpp v11, v25, v253 row_newbcast:12 row_mask:0xf bank_mask:0xf
    v_dot2c_f32_bf16_dpp v12, v24, v254 row_newbcast:12 row_mask:0xf bank_mask:0xf
    v_dot2c_f32_bf16_dpp v13, v25, v254 row_newbcast:12 row_mask:0xf bank_mask:0xf
    v_dot2c_f32_bf16_dpp v14, v24, v255 row_newbcast:12 row_mask:0xf bank_mask:0xf
    v_dot2c_f32_bf16_dpp v15, v25, v255 row_newbcast:12 row_mask:0xf bank_mask:0xf
    s_mov_b32 s46, 115200
    buffer_load_dwordx4 v[164:167], v32, s[20:23], s46 offen
    buffer_load_dwordx4 v[240:243], v1, s[8:11], s43 offen offset:0 sc0 sc1 nt
    buffer_load_dwordx4 v[244:247], v1, s[8:11], s43 offen offset:1024 sc0 sc1 nt
    buffer_load_dwordx4 v[248:251], v1, s[8:11], s43 offen offset:2048 sc0 sc1 nt
    buffer_load_dwordx4 v[252:255], v1, s[8:11], s43 offen offset:3072 sc0 sc1 nt
    s_setprio 2
    s_waitcnt vmcnt(35)
    v_dot2_f32_bf16 v20, v40, v16, 0
    v_dot2_f32_bf16 v21, v44, v16, 0
    v_dot2_f32_bf16 v22, v48, v16, 0
    v_dot2_f32_bf16 v23, v52, v16, 0
    v_dot2c_f32_bf16 v20, v41, v17
    v_dot2c_f32_bf16 v21, v45, v17
    v_dot2c_f32_bf16 v22, v49, v17
    v_dot2c_f32_bf16 v23, v53, v17
    v_dot2c_f32_bf16 v20, v42, v18
    v_dot2c_f32_bf16 v21, v46, v18
    v_dot2c_f32_bf16 v22, v50, v18
    v_dot2c_f32_bf16 v23, v54, v18
    v_dot2c_f32_bf16 v20, v43, v19
    v_dot2c_f32_bf16 v21, v47, v19
    v_dot2c_f32_bf16 v22, v51, v19
    v_dot2c_f32_bf16 v23, v55, v19
    s_mov_b32 s46, 122880
    buffer_load_dwordx4 v[168:171], v32, s[20:23], s46 offen
    s_add_u32 s43, s43, 32768
    buffer_load_dwordx4 v[40:43], v1, s[4:7], s43 offen offset:0 sc0 sc1 nt
    buffer_load_dwordx4 v[44:47], v1, s[4:7], s43 offen offset:1024 sc0 sc1 nt
    buffer_load_dwordx4 v[48:51], v1, s[4:7], s43 offen offset:2048 sc0 sc1 nt
    buffer_load_dwordx4 v[52:55], v1, s[4:7], s43 offen offset:3072 sc0 sc1 nt
    v_add_f32_dpp v20, v20, v20 row_ror:8 row_mask:0xf bank_mask:0x3
    v_add_f32_dpp v22, v22, v22 row_ror:8 row_mask:0xf bank_mask:0x3
    s_nop 0
    v_add_f32_dpp v20, v21, v21 row_ror:8 row_mask:0xf bank_mask:0xc
    v_add_f32_dpp v22, v23, v23 row_ror:8 row_mask:0xf bank_mask:0xc
    s_nop 0
    v_add_f32_dpp v20, v20, v20 row_half_mirror row_mask:0xf bank_mask:0x5
    s_nop 1
    v_add_f32_dpp v20, v22, v22 row_half_mirror row_mask:0xf bank_mask:0xa
    s_nop 1
    v_add_f32_dpp v20, v20, v20 quad_perm:[1,0,3,2] row_mask:0xf bank_mask:0xf
    s_nop 1
    v_add_f32_dpp v20, v20, v20 quad_perm:[2,3,0,1] row_mask:0xf bank_mask:0xf
    v_cvt_pk_bf16_f32 v20, v20, v20
    v_and_b32 v20, s50, v20
    v_mul_f32 v20, s51, v20
    v_cvt_pk_bf16_f32 v20, v20, v20
    v_and_b32 v20, s50, v20
    s_nop 1
    v_max_f32_dpp v21, v20, v20 row_ror:4 row_mask:0xf bank_mask:0xf
    s_nop 1
    v_max_f32_dpp v21, v21, v21 row_ror:8 row_mask:0xf bank_mask:0xf
    v_max_f32 v21, v21, v5
    v_sub_f32 v22, v5, v21
    v_sub_f32 v20, v20, v21
    v_mov_b32 v5, v21
    v_mul_f32 v22, s52, v22
    v_mul_f32 v20, s52, v20
    v_exp_f32 v26, v22
    v_exp_f32 v20, v20
    v_pk_mul_f32 v[8:9], v[8:9], v[26:27] op_sel_hi:[1,0]
    v_pk_mul_f32 v[10:11], v[10:11], v[26:27] op_sel_hi:[1,0]
    v_pk_mul_f32 v[12:13], v[12:13], v[26:27] op_sel_hi:[1,0]
    v_pk_mul_f32 v[14:15], v[14:15], v[26:27] op_sel_hi:[1,0]
    v_cvt_pk_bf16_f32 v24, v20, 0
    v_cvt_pk_bf16_f32 v25, 0, v20
    v_fma_f32 v6, v6, v26, v20
    s_waitcnt vmcnt(35)
    v_dot2c_f32_bf16_dpp v8, v24, v56 row_newbcast:0 row_mask:0xf bank_mask:0xf
    v_dot2c_f32_bf16_dpp v9, v25, v56 row_newbcast:0 row_mask:0xf bank_mask:0xf
    v_dot2c_f32_bf16_dpp v10, v24, v57 row_newbcast:0 row_mask:0xf bank_mask:0xf
    v_dot2c_f32_bf16_dpp v11, v25, v57 row_newbcast:0 row_mask:0xf bank_mask:0xf
    v_dot2c_f32_bf16_dpp v12, v24, v58 row_newbcast:0 row_mask:0xf bank_mask:0xf
    v_dot2c_f32_bf16_dpp v13, v25, v58 row_newbcast:0 row_mask:0xf bank_mask:0xf
    v_dot2c_f32_bf16_dpp v14, v24, v59 row_newbcast:0 row_mask:0xf bank_mask:0xf
    v_dot2c_f32_bf16_dpp v15, v25, v59 row_newbcast:0 row_mask:0xf bank_mask:0xf
    v_dot2c_f32_bf16_dpp v8, v24, v60 row_newbcast:8 row_mask:0xf bank_mask:0xf
    v_dot2c_f32_bf16_dpp v9, v25, v60 row_newbcast:8 row_mask:0xf bank_mask:0xf
    v_dot2c_f32_bf16_dpp v10, v24, v61 row_newbcast:8 row_mask:0xf bank_mask:0xf
    v_dot2c_f32_bf16_dpp v11, v25, v61 row_newbcast:8 row_mask:0xf bank_mask:0xf
    v_dot2c_f32_bf16_dpp v12, v24, v62 row_newbcast:8 row_mask:0xf bank_mask:0xf
    v_dot2c_f32_bf16_dpp v13, v25, v62 row_newbcast:8 row_mask:0xf bank_mask:0xf
    v_dot2c_f32_bf16_dpp v14, v24, v63 row_newbcast:8 row_mask:0xf bank_mask:0xf
    v_dot2c_f32_bf16_dpp v15, v25, v63 row_newbcast:8 row_mask:0xf bank_mask:0xf
    v_dot2c_f32_bf16_dpp v8, v24, v64 row_newbcast:4 row_mask:0xf bank_mask:0xf
    v_dot2c_f32_bf16_dpp v9, v25, v64 row_newbcast:4 row_mask:0xf bank_mask:0xf
    v_dot2c_f32_bf16_dpp v10, v24, v65 row_newbcast:4 row_mask:0xf bank_mask:0xf
    v_dot2c_f32_bf16_dpp v11, v25, v65 row_newbcast:4 row_mask:0xf bank_mask:0xf
    v_dot2c_f32_bf16_dpp v12, v24, v66 row_newbcast:4 row_mask:0xf bank_mask:0xf
    v_dot2c_f32_bf16_dpp v13, v25, v66 row_newbcast:4 row_mask:0xf bank_mask:0xf
    v_dot2c_f32_bf16_dpp v14, v24, v67 row_newbcast:4 row_mask:0xf bank_mask:0xf
    v_dot2c_f32_bf16_dpp v15, v25, v67 row_newbcast:4 row_mask:0xf bank_mask:0xf
    v_dot2c_f32_bf16_dpp v8, v24, v68 row_newbcast:12 row_mask:0xf bank_mask:0xf
    v_dot2c_f32_bf16_dpp v9, v25, v68 row_newbcast:12 row_mask:0xf bank_mask:0xf
    v_dot2c_f32_bf16_dpp v10, v24, v69 row_newbcast:12 row_mask:0xf bank_mask:0xf
    v_dot2c_f32_bf16_dpp v11, v25, v69 row_newbcast:12 row_mask:0xf bank_mask:0xf
    v_dot2c_f32_bf16_dpp v12, v24, v70 row_newbcast:12 row_mask:0xf bank_mask:0xf
    v_dot2c_f32_bf16_dpp v13, v25, v70 row_newbcast:12 row_mask:0xf bank_mask:0xf
    v_dot2c_f32_bf16_dpp v14, v24, v71 row_newbcast:12 row_mask:0xf bank_mask:0xf
    v_dot2c_f32_bf16_dpp v15, v25, v71 row_newbcast:12 row_mask:0xf bank_mask:0xf
    s_mov_b32 s46, 130560
    buffer_load_dwordx4 v[172:175], v32, s[20:23], s46 offen
    buffer_load_dwordx4 v[56:59], v1, s[8:11], s43 offen offset:0 sc0 sc1 nt
    buffer_load_dwordx4 v[60:63], v1, s[8:11], s43 offen offset:1024 sc0 sc1 nt
    buffer_load_dwordx4 v[64:67], v1, s[8:11], s43 offen offset:2048 sc0 sc1 nt
    buffer_load_dwordx4 v[68:71], v1, s[8:11], s43 offen offset:3072 sc0 sc1 nt
    s_waitcnt vmcnt(35)
    v_dot2_f32_bf16 v20, v72, v16, 0
    v_dot2_f32_bf16 v21, v76, v16, 0
    v_dot2_f32_bf16 v22, v80, v16, 0
    v_dot2_f32_bf16 v23, v84, v16, 0
    v_dot2c_f32_bf16 v20, v73, v17
    v_dot2c_f32_bf16 v21, v77, v17
    v_dot2c_f32_bf16 v22, v81, v17
    v_dot2c_f32_bf16 v23, v85, v17
    v_dot2c_f32_bf16 v20, v74, v18
    v_dot2c_f32_bf16 v21, v78, v18
    v_dot2c_f32_bf16 v22, v82, v18
    v_dot2c_f32_bf16 v23, v86, v18
    v_dot2c_f32_bf16 v20, v75, v19
    v_dot2c_f32_bf16 v21, v79, v19
    v_dot2c_f32_bf16 v22, v83, v19
    v_dot2c_f32_bf16 v23, v87, v19
    s_mov_b32 s46, 138240
    buffer_load_dwordx4 v[176:179], v32, s[20:23], s46 offen
    s_add_u32 s43, s43, 32768
    buffer_load_dwordx4 v[72:75], v1, s[4:7], s43 offen offset:0 sc0 sc1 nt
    buffer_load_dwordx4 v[76:79], v1, s[4:7], s43 offen offset:1024 sc0 sc1 nt
    buffer_load_dwordx4 v[80:83], v1, s[4:7], s43 offen offset:2048 sc0 sc1 nt
    buffer_load_dwordx4 v[84:87], v1, s[4:7], s43 offen offset:3072 sc0 sc1 nt
    v_add_f32_dpp v20, v20, v20 row_ror:8 row_mask:0xf bank_mask:0x3
    v_add_f32_dpp v22, v22, v22 row_ror:8 row_mask:0xf bank_mask:0x3
    s_nop 0
    v_add_f32_dpp v20, v21, v21 row_ror:8 row_mask:0xf bank_mask:0xc
    v_add_f32_dpp v22, v23, v23 row_ror:8 row_mask:0xf bank_mask:0xc
    s_nop 0
    v_add_f32_dpp v20, v20, v20 row_half_mirror row_mask:0xf bank_mask:0x5
    s_nop 1
    v_add_f32_dpp v20, v22, v22 row_half_mirror row_mask:0xf bank_mask:0xa
    s_nop 1
    v_add_f32_dpp v20, v20, v20 quad_perm:[1,0,3,2] row_mask:0xf bank_mask:0xf
    s_nop 1
    v_add_f32_dpp v20, v20, v20 quad_perm:[2,3,0,1] row_mask:0xf bank_mask:0xf
    v_cvt_pk_bf16_f32 v20, v20, v20
    v_and_b32 v20, s50, v20
    v_mul_f32 v20, s51, v20
    v_cvt_pk_bf16_f32 v20, v20, v20
    v_and_b32 v20, s50, v20
    s_nop 1
    v_max_f32_dpp v21, v20, v20 row_ror:4 row_mask:0xf bank_mask:0xf
    s_nop 1
    v_max_f32_dpp v21, v21, v21 row_ror:8 row_mask:0xf bank_mask:0xf
    v_max_f32 v21, v21, v5
    v_sub_f32 v22, v5, v21
    v_sub_f32 v20, v20, v21
    v_mov_b32 v5, v21
    v_mul_f32 v22, s52, v22
    v_mul_f32 v20, s52, v20
    v_exp_f32 v26, v22
    v_exp_f32 v20, v20
    v_pk_mul_f32 v[8:9], v[8:9], v[26:27] op_sel_hi:[1,0]
    v_pk_mul_f32 v[10:11], v[10:11], v[26:27] op_sel_hi:[1,0]
    v_pk_mul_f32 v[12:13], v[12:13], v[26:27] op_sel_hi:[1,0]
    v_pk_mul_f32 v[14:15], v[14:15], v[26:27] op_sel_hi:[1,0]
    v_cvt_pk_bf16_f32 v24, v20, 0
    v_cvt_pk_bf16_f32 v25, 0, v20
    v_fma_f32 v6, v6, v26, v20
    s_waitcnt vmcnt(35)
    v_dot2c_f32_bf16_dpp v8, v24, v88 row_newbcast:0 row_mask:0xf bank_mask:0xf
    v_dot2c_f32_bf16_dpp v9, v25, v88 row_newbcast:0 row_mask:0xf bank_mask:0xf
    v_dot2c_f32_bf16_dpp v10, v24, v89 row_newbcast:0 row_mask:0xf bank_mask:0xf
    v_dot2c_f32_bf16_dpp v11, v25, v89 row_newbcast:0 row_mask:0xf bank_mask:0xf
    v_dot2c_f32_bf16_dpp v12, v24, v90 row_newbcast:0 row_mask:0xf bank_mask:0xf
    v_dot2c_f32_bf16_dpp v13, v25, v90 row_newbcast:0 row_mask:0xf bank_mask:0xf
    v_dot2c_f32_bf16_dpp v14, v24, v91 row_newbcast:0 row_mask:0xf bank_mask:0xf
    v_dot2c_f32_bf16_dpp v15, v25, v91 row_newbcast:0 row_mask:0xf bank_mask:0xf
    v_dot2c_f32_bf16_dpp v8, v24, v92 row_newbcast:8 row_mask:0xf bank_mask:0xf
    v_dot2c_f32_bf16_dpp v9, v25, v92 row_newbcast:8 row_mask:0xf bank_mask:0xf
    v_dot2c_f32_bf16_dpp v10, v24, v93 row_newbcast:8 row_mask:0xf bank_mask:0xf
    v_dot2c_f32_bf16_dpp v11, v25, v93 row_newbcast:8 row_mask:0xf bank_mask:0xf
    v_dot2c_f32_bf16_dpp v12, v24, v94 row_newbcast:8 row_mask:0xf bank_mask:0xf
    v_dot2c_f32_bf16_dpp v13, v25, v94 row_newbcast:8 row_mask:0xf bank_mask:0xf
    v_dot2c_f32_bf16_dpp v14, v24, v95 row_newbcast:8 row_mask:0xf bank_mask:0xf
    v_dot2c_f32_bf16_dpp v15, v25, v95 row_newbcast:8 row_mask:0xf bank_mask:0xf
    v_dot2c_f32_bf16_dpp v8, v24, v96 row_newbcast:4 row_mask:0xf bank_mask:0xf
    v_dot2c_f32_bf16_dpp v9, v25, v96 row_newbcast:4 row_mask:0xf bank_mask:0xf
    v_dot2c_f32_bf16_dpp v10, v24, v97 row_newbcast:4 row_mask:0xf bank_mask:0xf
    v_dot2c_f32_bf16_dpp v11, v25, v97 row_newbcast:4 row_mask:0xf bank_mask:0xf
    v_dot2c_f32_bf16_dpp v12, v24, v98 row_newbcast:4 row_mask:0xf bank_mask:0xf
    v_dot2c_f32_bf16_dpp v13, v25, v98 row_newbcast:4 row_mask:0xf bank_mask:0xf
    v_dot2c_f32_bf16_dpp v14, v24, v99 row_newbcast:4 row_mask:0xf bank_mask:0xf
    v_dot2c_f32_bf16_dpp v15, v25, v99 row_newbcast:4 row_mask:0xf bank_mask:0xf
    v_dot2c_f32_bf16_dpp v8, v24, v100 row_newbcast:12 row_mask:0xf bank_mask:0xf
    v_dot2c_f32_bf16_dpp v9, v25, v100 row_newbcast:12 row_mask:0xf bank_mask:0xf
    v_dot2c_f32_bf16_dpp v10, v24, v101 row_newbcast:12 row_mask:0xf bank_mask:0xf
    v_dot2c_f32_bf16_dpp v11, v25, v101 row_newbcast:12 row_mask:0xf bank_mask:0xf
    v_dot2c_f32_bf16_dpp v12, v24, v102 row_newbcast:12 row_mask:0xf bank_mask:0xf
    v_dot2c_f32_bf16_dpp v13, v25, v102 row_newbcast:12 row_mask:0xf bank_mask:0xf
    v_dot2c_f32_bf16_dpp v14, v24, v103 row_newbcast:12 row_mask:0xf bank_mask:0xf
    v_dot2c_f32_bf16_dpp v15, v25, v103 row_newbcast:12 row_mask:0xf bank_mask:0xf
    buffer_load_dwordx4 v[88:91], v1, s[8:11], s43 offen offset:0 sc0 sc1 nt
    buffer_load_dwordx4 v[92:95], v1, s[8:11], s43 offen offset:1024 sc0 sc1 nt
    buffer_load_dwordx4 v[96:99], v1, s[8:11], s43 offen offset:2048 sc0 sc1 nt
    buffer_load_dwordx4 v[100:103], v1, s[8:11], s43 offen offset:3072 sc0 sc1 nt
    s_waitcnt vmcnt(34)
    v_dot2_f32_bf16 v20, v192, v16, 0
    v_dot2_f32_bf16 v21, v196, v16, 0
    v_dot2_f32_bf16 v22, v200, v16, 0
    v_dot2_f32_bf16 v23, v204, v16, 0
    v_dot2c_f32_bf16 v20, v193, v17
    v_dot2c_f32_bf16 v21, v197, v17
    v_dot2c_f32_bf16 v22, v201, v17
    v_dot2c_f32_bf16 v23, v205, v17
    v_dot2c_f32_bf16 v20, v194, v18
    v_dot2c_f32_bf16 v21, v198, v18
    v_dot2c_f32_bf16 v22, v202, v18
    v_dot2c_f32_bf16 v23, v206, v18
    v_dot2c_f32_bf16 v20, v195, v19
    v_dot2c_f32_bf16 v21, v199, v19
    v_dot2c_f32_bf16 v22, v203, v19
    v_dot2c_f32_bf16 v23, v207, v19
    s_mov_b32 s46, 145920
    buffer_load_dwordx4 v[180:183], v32, s[20:23], s46 offen
    s_add_u32 s43, s43, 32768
    buffer_load_dwordx4 v[192:195], v1, s[4:7], s43 offen offset:0 sc0 sc1 nt
    buffer_load_dwordx4 v[196:199], v1, s[4:7], s43 offen offset:1024 sc0 sc1 nt
    buffer_load_dwordx4 v[200:203], v1, s[4:7], s43 offen offset:2048 sc0 sc1 nt
    buffer_load_dwordx4 v[204:207], v1, s[4:7], s43 offen offset:3072 sc0 sc1 nt
    v_add_f32_dpp v20, v20, v20 row_ror:8 row_mask:0xf bank_mask:0x3
    v_add_f32_dpp v22, v22, v22 row_ror:8 row_mask:0xf bank_mask:0x3
    s_nop 0
    v_add_f32_dpp v20, v21, v21 row_ror:8 row_mask:0xf bank_mask:0xc
    v_add_f32_dpp v22, v23, v23 row_ror:8 row_mask:0xf bank_mask:0xc
    s_nop 0
    v_add_f32_dpp v20, v20, v20 row_half_mirror row_mask:0xf bank_mask:0x5
    s_nop 1
    v_add_f32_dpp v20, v22, v22 row_half_mirror row_mask:0xf bank_mask:0xa
    s_nop 1
    v_add_f32_dpp v20, v20, v20 quad_perm:[1,0,3,2] row_mask:0xf bank_mask:0xf
    s_nop 1
    v_add_f32_dpp v20, v20, v20 quad_perm:[2,3,0,1] row_mask:0xf bank_mask:0xf
    v_cvt_pk_bf16_f32 v20, v20, v20
    v_and_b32 v20, s50, v20
    v_mul_f32 v20, s51, v20
    v_cvt_pk_bf16_f32 v20, v20, v20
    v_and_b32 v20, s50, v20
    s_nop 1
    v_max_f32_dpp v21, v20, v20 row_ror:4 row_mask:0xf bank_mask:0xf
    s_nop 1
    v_max_f32_dpp v21, v21, v21 row_ror:8 row_mask:0xf bank_mask:0xf
    v_max_f32 v21, v21, v5
    v_sub_f32 v22, v5, v21
    v_sub_f32 v20, v20, v21
    v_mov_b32 v5, v21
    v_mul_f32 v22, s52, v22
    v_mul_f32 v20, s52, v20
    v_exp_f32 v26, v22
    v_exp_f32 v20, v20
    v_pk_mul_f32 v[8:9], v[8:9], v[26:27] op_sel_hi:[1,0]
    v_pk_mul_f32 v[10:11], v[10:11], v[26:27] op_sel_hi:[1,0]
    v_pk_mul_f32 v[12:13], v[12:13], v[26:27] op_sel_hi:[1,0]
    v_pk_mul_f32 v[14:15], v[14:15], v[26:27] op_sel_hi:[1,0]
    v_cvt_pk_bf16_f32 v24, v20, 0
    v_cvt_pk_bf16_f32 v25, 0, v20
    v_fma_f32 v6, v6, v26, v20
    s_waitcnt vmcnt(34)
    v_dot2c_f32_bf16_dpp v8, v24, v208 row_newbcast:0 row_mask:0xf bank_mask:0xf
    v_dot2c_f32_bf16_dpp v9, v25, v208 row_newbcast:0 row_mask:0xf bank_mask:0xf
    v_dot2c_f32_bf16_dpp v10, v24, v209 row_newbcast:0 row_mask:0xf bank_mask:0xf
    v_dot2c_f32_bf16_dpp v11, v25, v209 row_newbcast:0 row_mask:0xf bank_mask:0xf
    v_dot2c_f32_bf16_dpp v12, v24, v210 row_newbcast:0 row_mask:0xf bank_mask:0xf
    v_dot2c_f32_bf16_dpp v13, v25, v210 row_newbcast:0 row_mask:0xf bank_mask:0xf
    v_dot2c_f32_bf16_dpp v14, v24, v211 row_newbcast:0 row_mask:0xf bank_mask:0xf
    v_dot2c_f32_bf16_dpp v15, v25, v211 row_newbcast:0 row_mask:0xf bank_mask:0xf
    v_dot2c_f32_bf16_dpp v8, v24, v212 row_newbcast:8 row_mask:0xf bank_mask:0xf
    v_dot2c_f32_bf16_dpp v9, v25, v212 row_newbcast:8 row_mask:0xf bank_mask:0xf
    v_dot2c_f32_bf16_dpp v10, v24, v213 row_newbcast:8 row_mask:0xf bank_mask:0xf
    v_dot2c_f32_bf16_dpp v11, v25, v213 row_newbcast:8 row_mask:0xf bank_mask:0xf
    v_dot2c_f32_bf16_dpp v12, v24, v214 row_newbcast:8 row_mask:0xf bank_mask:0xf
    v_dot2c_f32_bf16_dpp v13, v25, v214 row_newbcast:8 row_mask:0xf bank_mask:0xf
    v_dot2c_f32_bf16_dpp v14, v24, v215 row_newbcast:8 row_mask:0xf bank_mask:0xf
    v_dot2c_f32_bf16_dpp v15, v25, v215 row_newbcast:8 row_mask:0xf bank_mask:0xf
    v_dot2c_f32_bf16_dpp v8, v24, v216 row_newbcast:4 row_mask:0xf bank_mask:0xf
    v_dot2c_f32_bf16_dpp v9, v25, v216 row_newbcast:4 row_mask:0xf bank_mask:0xf
    v_dot2c_f32_bf16_dpp v10, v24, v217 row_newbcast:4 row_mask:0xf bank_mask:0xf
    v_dot2c_f32_bf16_dpp v11, v25, v217 row_newbcast:4 row_mask:0xf bank_mask:0xf
    v_dot2c_f32_bf16_dpp v12, v24, v218 row_newbcast:4 row_mask:0xf bank_mask:0xf
    v_dot2c_f32_bf16_dpp v13, v25, v218 row_newbcast:4 row_mask:0xf bank_mask:0xf
    v_dot2c_f32_bf16_dpp v14, v24, v219 row_newbcast:4 row_mask:0xf bank_mask:0xf
    v_dot2c_f32_bf16_dpp v15, v25, v219 row_newbcast:4 row_mask:0xf bank_mask:0xf
    v_dot2c_f32_bf16_dpp v8, v24, v220 row_newbcast:12 row_mask:0xf bank_mask:0xf
    v_dot2c_f32_bf16_dpp v9, v25, v220 row_newbcast:12 row_mask:0xf bank_mask:0xf
    v_dot2c_f32_bf16_dpp v10, v24, v221 row_newbcast:12 row_mask:0xf bank_mask:0xf
    v_dot2c_f32_bf16_dpp v11, v25, v221 row_newbcast:12 row_mask:0xf bank_mask:0xf
    v_dot2c_f32_bf16_dpp v12, v24, v222 row_newbcast:12 row_mask:0xf bank_mask:0xf
    v_dot2c_f32_bf16_dpp v13, v25, v222 row_newbcast:12 row_mask:0xf bank_mask:0xf
    v_dot2c_f32_bf16_dpp v14, v24, v223 row_newbcast:12 row_mask:0xf bank_mask:0xf
    v_dot2c_f32_bf16_dpp v15, v25, v223 row_newbcast:12 row_mask:0xf bank_mask:0xf
    s_cmp_lg_u32 s40, 0
    s_cbranch_scc1 L_chk1_done
    s_mov_b32 s55, 0x40000
L_chk1:
    v_cmp_gt_u32 vcc, 64, v28
    s_cbranch_vccz L_chk1_ok
    s_sleep 32
    v_lshlrev_b32 v7, 2, v1
    v_and_b32 v7, 0xc0, v7
    global_load_dword v28, v7, s[84:85] sc1
    s_waitcnt vmcnt(0)
    s_sub_u32 s55, s55, 1
    s_cbranch_scc0 L_chk1
L_chk1_ok:
    ds_write_b32 v2, v3 offset:4
L_chk1_done:
    s_mov_b32 s46, 153600
    buffer_load_dwordx4 v[184:187], v32, s[20:23], s46 offen
    buffer_load_dwordx4 v[208:211], v1, s[8:11], s43 offen offset:0 sc0 sc1 nt
    buffer_load_dwordx4 v[212:215], v1, s[8:11], s43 offen offset:1024 sc0 sc1 nt
    buffer_load_dwordx4 v[216:219], v1, s[8:11], s43 offen offset:2048 sc0 sc1 nt
    buffer_load_dwordx4 v[220:223], v1, s[8:11], s43 offen offset:3072 sc0 sc1 nt
    s_waitcnt vmcnt(34)
    v_dot2_f32_bf16 v20, v224, v16, 0
    v_dot2_f32_bf16 v21, v228, v16, 0
    v_dot2_f32_bf16 v22, v232, v16, 0
    v_dot2_f32_bf16 v23, v236, v16, 0
    v_dot2c_f32_bf16 v20, v225, v17
    v_dot2c_f32_bf16 v21, v229, v17
    v_dot2c_f32_bf16 v22, v233, v17
    v_dot2c_f32_bf16 v23, v237, v17
    v_dot2c_f32_bf16 v20, v226, v18
    v_dot2c_f32_bf16 v21, v230, v18
    v_dot2c_f32_bf16 v22, v234, v18
    v_dot2c_f32_bf16 v23, v238, v18
    v_dot2c_f32_bf16 v20, v227, v19
    v_dot2c_f32_bf16 v21, v231, v19
    v_dot2c_f32_bf16 v22, v235, v19
    v_dot2c_f32_bf16 v23, v239, v19
    v_add_u32 v7, 161280, v32
    buffer_load_dwordx4 v[188:191], v7, s[20:23], 0 offen
    s_add_u32 s43, s43, 32768
    buffer_load_dwordx4 v[224:227], v1, s[4:7], s43 offen offset:0 sc0 sc1 nt
    buffer_load_dwordx4 v[228:231], v1, s[4:7], s43 offen offset:1024 sc0 sc1 nt
    buffer_load_dwordx4 v[232:235], v1, s[4:7], s43 offen offset:2048 sc0 sc1 nt
    buffer_load_dwordx4 v[236:239], v1, s[4:7], s43 offen offset:3072 sc0 sc1 nt
    v_add_f32_dpp v20, v20, v20 row_ror:8 row_mask:0xf bank_mask:0x3
    v_add_f32_dpp v22, v22, v22 row_ror:8 row_mask:0xf bank_mask:0x3
    s_nop 0
    v_add_f32_dpp v20, v21, v21 row_ror:8 row_mask:0xf bank_mask:0xc
    v_add_f32_dpp v22, v23, v23 row_ror:8 row_mask:0xf bank_mask:0xc
    s_nop 0
    v_add_f32_dpp v20, v20, v20 row_half_mirror row_mask:0xf bank_mask:0x5
    s_nop 1
    v_add_f32_dpp v20, v22, v22 row_half_mirror row_mask:0xf bank_mask:0xa
    s_nop 1
    v_add_f32_dpp v20, v20, v20 quad_perm:[1,0,3,2] row_mask:0xf bank_mask:0xf
    s_nop 1
    v_add_f32_dpp v20, v20, v20 quad_perm:[2,3,0,1] row_mask:0xf bank_mask:0xf
    v_cvt_pk_bf16_f32 v20, v20, v20
    v_and_b32 v20, s50, v20
    v_mul_f32 v20, s51, v20
    v_cvt_pk_bf16_f32 v20, v20, v20
    v_and_b32 v20, s50, v20
    s_nop 1
    v_max_f32_dpp v21, v20, v20 row_ror:4 row_mask:0xf bank_mask:0xf
    s_nop 1
    v_max_f32_dpp v21, v21, v21 row_ror:8 row_mask:0xf bank_mask:0xf
    v_max_f32 v21, v21, v5
    v_sub_f32 v22, v5, v21
    v_sub_f32 v20, v20, v21
    v_mov_b32 v5, v21
    v_mul_f32 v22, s52, v22
    v_mul_f32 v20, s52, v20
    v_exp_f32 v26, v22
    v_exp_f32 v20, v20
    v_pk_mul_f32 v[8:9], v[8:9], v[26:27] op_sel_hi:[1,0]
    v_pk_mul_f32 v[10:11], v[10:11], v[26:27] op_sel_hi:[1,0]
    v_pk_mul_f32 v[12:13], v[12:13], v[26:27] op_sel_hi:[1,0]
    v_pk_mul_f32 v[14:15], v[14:15], v[26:27] op_sel_hi:[1,0]
    v_cvt_pk_bf16_f32 v24, v20, 0
    v_cvt_pk_bf16_f32 v25, 0, v20
    v_fma_f32 v6, v6, v26, v20
    s_waitcnt vmcnt(34)
    v_dot2c_f32_bf16_dpp v8, v24, v240 row_newbcast:0 row_mask:0xf bank_mask:0xf
    v_dot2c_f32_bf16_dpp v9, v25, v240 row_newbcast:0 row_mask:0xf bank_mask:0xf
    v_dot2c_f32_bf16_dpp v10, v24, v241 row_newbcast:0 row_mask:0xf bank_mask:0xf
    v_dot2c_f32_bf16_dpp v11, v25, v241 row_newbcast:0 row_mask:0xf bank_mask:0xf
    v_dot2c_f32_bf16_dpp v12, v24, v242 row_newbcast:0 row_mask:0xf bank_mask:0xf
    v_dot2c_f32_bf16_dpp v13, v25, v242 row_newbcast:0 row_mask:0xf bank_mask:0xf
    v_dot2c_f32_bf16_dpp v14, v24, v243 row_newbcast:0 row_mask:0xf bank_mask:0xf
    v_dot2c_f32_bf16_dpp v15, v25, v243 row_newbcast:0 row_mask:0xf bank_mask:0xf
    v_dot2c_f32_bf16_dpp v8, v24, v244 row_newbcast:8 row_mask:0xf bank_mask:0xf
    v_dot2c_f32_bf16_dpp v9, v25, v244 row_newbcast:8 row_mask:0xf bank_mask:0xf
    v_dot2c_f32_bf16_dpp v10, v24, v245 row_newbcast:8 row_mask:0xf bank_mask:0xf
    v_dot2c_f32_bf16_dpp v11, v25, v245 row_newbcast:8 row_mask:0xf bank_mask:0xf
    v_dot2c_f32_bf16_dpp v12, v24, v246 row_newbcast:8 row_mask:0xf bank_mask:0xf
    v_dot2c_f32_bf16_dpp v13, v25, v246 row_newbcast:8 row_mask:0xf bank_mask:0xf
    v_dot2c_f32_bf16_dpp v14, v24, v247 row_newbcast:8 row_mask:0xf bank_mask:0xf
    v_dot2c_f32_bf16_dpp v15, v25, v247 row_newbcast:8 row_mask:0xf bank_mask:0xf
    v_dot2c_f32_bf16_dpp v8, v24, v248 row_newbcast:4 row_mask:0xf bank_mask:0xf
    v_dot2c_f32_bf16_dpp v9, v25, v248 row_newbcast:4 row_mask:0xf bank_mask:0xf
    v_dot2c_f32_bf16_dpp v10, v24, v249 row_newbcast:4 row_mask:0xf bank_mask:0xf
    v_dot2c_f32_bf16_dpp v11, v25, v249 row_newbcast:4 row_mask:0xf bank_mask:0xf
    v_dot2c_f32_bf16_dpp v12, v24, v250 row_newbcast:4 row_mask:0xf bank_mask:0xf
    v_dot2c_f32_bf16_dpp v13, v25, v250 row_newbcast:4 row_mask:0xf bank_mask:0xf
    v_dot2c_f32_bf16_dpp v14, v24, v251 row_newbcast:4 row_mask:0xf bank_mask:0xf
    v_dot2c_f32_bf16_dpp v15, v25, v251 row_newbcast:4 row_mask:0xf bank_mask:0xf
    v_dot2c_f32_bf16_dpp v8, v24, v252 row_newbcast:12 row_mask:0xf bank_mask:0xf
    v_dot2c_f32_bf16_dpp v9, v25, v252 row_newbcast:12 row_mask:0xf bank_mask:0xf
    v_dot2c_f32_bf16_dpp v10, v24, v253 row_newbcast:12 row_mask:0xf bank_mask:0xf
    v_dot2c_f32_bf16_dpp v11, v25, v253 row_newbcast:12 row_mask:0xf bank_mask:0xf
    v_dot2c_f32_bf16_dpp v12, v24, v254 row_newbcast:12 row_mask:0xf bank_mask:0xf
    v_dot2c_f32_bf16_dpp v13, v25, v254 row_newbcast:12 row_mask:0xf bank_mask:0xf
    v_dot2c_f32_bf16_dpp v14, v24, v255 row_newbcast:12 row_mask:0xf bank_mask:0xf
    v_dot2c_f32_bf16_dpp v15, v25, v255 row_newbcast:12 row_mask:0xf bank_mask:0xf
    s_add_u32 m0, s49, 0
    s_nop 0
    global_load_lds_dwordx4 v[34:35], off
    v_lshl_add_u64 v[34:35], s[38:39], 0, v[34:35]
    buffer_load_dwordx4 v[240:243], v1, s[8:11], s43 offen offset:0 sc0 sc1 nt
    buffer_load_dwordx4 v[244:247], v1, s[8:11], s43 offen offset:1024 sc0 sc1 nt
    buffer_load_dwordx4 v[248:251], v1, s[8:11], s43 offen offset:2048 sc0 sc1 nt
    buffer_load_dwordx4 v[252:255], v1, s[8:11], s43 offen offset:3072 sc0 sc1 nt
    s_waitcnt vmcnt(34)
    v_dot2_f32_bf16 v20, v40, v16, 0
    v_dot2_f32_bf16 v21, v44, v16, 0
    v_dot2_f32_bf16 v22, v48, v16, 0
    v_dot2_f32_bf16 v23, v52, v16, 0
    v_dot2c_f32_bf16 v20, v41, v17
    v_dot2c_f32_bf16 v21, v45, v17
    v_dot2c_f32_bf16 v22, v49, v17
    v_dot2c_f32_bf16 v23, v53, v17
    v_dot2c_f32_bf16 v20, v42, v18
    v_dot2c_f32_bf16 v21, v46, v18
    v_dot2c_f32_bf16 v22, v50, v18
    v_dot2c_f32_bf16 v23, v54, v18
    v_dot2c_f32_bf16 v20, v43, v19
    v_dot2c_f32_bf16 v21, v47, v19
    v_dot2c_f32_bf16 v22, v51, v19
    v_dot2c_f32_bf16 v23, v55, v19
    s_add_u32 m0, s49, 8192
    s_nop 0
    global_load_lds_dwordx4 v[34:35], off
    v_lshl_add_u64 v[34:35], s[38:39], 0, v[34:35]
    s_add_u32 s43, s43, 32768
    buffer_load_dwordx4 v[40:43], v1, s[4:7], s43 offen offset:0 sc0 sc1 nt
    buffer_load_dwordx4 v[44:47], v1, s[4:7], s43 offen offset:1024 sc0 sc1 nt
    buffer_load_dwordx4 v[48:51], v1, s[4:7], s43 offen offset:2048 sc0 sc1 nt
    buffer_load_dwordx4 v[52:55], v1, s[4:7], s43 offen offset:3072 sc0 sc1 nt
    v_add_f32_dpp v20, v20, v20 row_ror:8 row_mask:0xf bank_mask:0x3
    v_add_f32_dpp v22, v22, v22 row_ror:8 row_mask:0xf bank_mask:0x3
    s_nop 0
    v_add_f32_dpp v20, v21, v21 row_ror:8 row_mask:0xf bank_mask:0xc
    v_add_f32_dpp v22, v23, v23 row_ror:8 row_mask:0xf bank_mask:0xc
    s_nop 0
    v_add_f32_dpp v20, v20, v20 row_half_mirror row_mask:0xf bank_mask:0x5
    s_nop 1
    v_add_f32_dpp v20, v22, v22 row_half_mirror row_mask:0xf bank_mask:0xa
    s_nop 1
    v_add_f32_dpp v20, v20, v20 quad_perm:[1,0,3,2] row_mask:0xf bank_mask:0xf
    s_nop 1
    v_add_f32_dpp v20, v20, v20 quad_perm:[2,3,0,1] row_mask:0xf bank_mask:0xf
    v_cvt_pk_bf16_f32 v20, v20, v20
    v_and_b32 v20, s50, v20
    v_mul_f32 v20, s51, v20
    v_cvt_pk_bf16_f32 v20, v20, v20
    v_and_b32 v20, s50, v20
    s_nop 1
    v_max_f32_dpp v21, v20, v20 row_ror:4 row_mask:0xf bank_mask:0xf
    s_nop 1
    v_max_f32_dpp v21, v21, v21 row_ror:8 row_mask:0xf bank_mask:0xf
    v_max_f32 v21, v21, v5
    v_sub_f32 v22, v5, v21
    v_sub_f32 v20, v20, v21
    v_mov_b32 v5, v21
    v_mul_f32 v22, s52, v22
    v_mul_f32 v20, s52, v20
    v_exp_f32 v26, v22
    v_exp_f32 v20, v20
    v_pk_mul_f32 v[8:9], v[8:9], v[26:27] op_sel_hi:[1,0]
    v_pk_mul_f32 v[10:11], v[10:11], v[26:27] op_sel_hi:[1,0]
    v_pk_mul_f32 v[12:13], v[12:13], v[26:27] op_sel_hi:[1,0]
    v_pk_mul_f32 v[14:15], v[14:15], v[26:27] op_sel_hi:[1,0]
    v_cvt_pk_bf16_f32 v24, v20, 0
    v_cvt_pk_bf16_f32 v25, 0, v20
    v_fma_f32 v6, v6, v26, v20
    s_waitcnt vmcnt(34)
    v_dot2c_f32_bf16_dpp v8, v24, v56 row_newbcast:0 row_mask:0xf bank_mask:0xf
    v_dot2c_f32_bf16_dpp v9, v25, v56 row_newbcast:0 row_mask:0xf bank_mask:0xf
    v_dot2c_f32_bf16_dpp v10, v24, v57 row_newbcast:0 row_mask:0xf bank_mask:0xf
    v_dot2c_f32_bf16_dpp v11, v25, v57 row_newbcast:0 row_mask:0xf bank_mask:0xf
    v_dot2c_f32_bf16_dpp v12, v24, v58 row_newbcast:0 row_mask:0xf bank_mask:0xf
    v_dot2c_f32_bf16_dpp v13, v25, v58 row_newbcast:0 row_mask:0xf bank_mask:0xf
    v_dot2c_f32_bf16_dpp v14, v24, v59 row_newbcast:0 row_mask:0xf bank_mask:0xf
    v_dot2c_f32_bf16_dpp v15, v25, v59 row_newbcast:0 row_mask:0xf bank_mask:0xf
    v_dot2c_f32_bf16_dpp v8, v24, v60 row_newbcast:8 row_mask:0xf bank_mask:0xf
    v_dot2c_f32_bf16_dpp v9, v25, v60 row_newbcast:8 row_mask:0xf bank_mask:0xf
    v_dot2c_f32_bf16_dpp v10, v24, v61 row_newbcast:8 row_mask:0xf bank_mask:0xf
    v_dot2c_f32_bf16_dpp v11, v25, v61 row_newbcast:8 row_mask:0xf bank_mask:0xf
    v_dot2c_f32_bf16_dpp v12, v24, v62 row_newbcast:8 row_mask:0xf bank_mask:0xf
    v_dot2c_f32_bf16_dpp v13, v25, v62 row_newbcast:8 row_mask:0xf bank_mask:0xf
    v_dot2c_f32_bf16_dpp v14, v24, v63 row_newbcast:8 row_mask:0xf bank_mask:0xf
    v_dot2c_f32_bf16_dpp v15, v25, v63 row_newbcast:8 row_mask:0xf bank_mask:0xf
    v_dot2c_f32_bf16_dpp v8, v24, v64 row_newbcast:4 row_mask:0xf bank_mask:0xf
    v_dot2c_f32_bf16_dpp v9, v25, v64 row_newbcast:4 row_mask:0xf bank_mask:0xf
    v_dot2c_f32_bf16_dpp v10, v24, v65 row_newbcast:4 row_mask:0xf bank_mask:0xf
    v_dot2c_f32_bf16_dpp v11, v25, v65 row_newbcast:4 row_mask:0xf bank_mask:0xf
    v_dot2c_f32_bf16_dpp v12, v24, v66 row_newbcast:4 row_mask:0xf bank_mask:0xf
    v_dot2c_f32_bf16_dpp v13, v25, v66 row_newbcast:4 row_mask:0xf bank_mask:0xf
    v_dot2c_f32_bf16_dpp v14, v24, v67 row_newbcast:4 row_mask:0xf bank_mask:0xf
    v_dot2c_f32_bf16_dpp v15, v25, v67 row_newbcast:4 row_mask:0xf bank_mask:0xf
    v_dot2c_f32_bf16_dpp v8, v24, v68 row_newbcast:12 row_mask:0xf bank_mask:0xf
    v_dot2c_f32_bf16_dpp v9, v25, v68 row_newbcast:12 row_mask:0xf bank_mask:0xf
    v_dot2c_f32_bf16_dpp v10, v24, v69 row_newbcast:12 row_mask:0xf bank_mask:0xf
    v_dot2c_f32_bf16_dpp v11, v25, v69 row_newbcast:12 row_mask:0xf bank_mask:0xf
    v_dot2c_f32_bf16_dpp v12, v24, v70 row_newbcast:12 row_mask:0xf bank_mask:0xf
    v_dot2c_f32_bf16_dpp v13, v25, v70 row_newbcast:12 row_mask:0xf bank_mask:0xf
    v_dot2c_f32_bf16_dpp v14, v24, v71 row_newbcast:12 row_mask:0xf bank_mask:0xf
    v_dot2c_f32_bf16_dpp v15, v25, v71 row_newbcast:12 row_mask:0xf bank_mask:0xf
    s_add_u32 m0, s49, 16384
    s_nop 0
    global_load_lds_dwordx4 v[34:35], off
    v_lshl_add_u64 v[34:35], s[38:39], 0, v[34:35]
    buffer_load_dwordx4 v[56:59], v1, s[8:11], s43 offen offset:0 sc0 sc1 nt
    buffer_load_dwordx4 v[60:63], v1, s[8:11], s43 offen offset:1024 sc0 sc1 nt
    buffer_load_dwordx4 v[64:67], v1, s[8:11], s43 offen offset:2048 sc0 sc1 nt
    buffer_load_dwordx4 v[68:71], v1, s[8:11], s43 offen offset:3072 sc0 sc1 nt
    s_waitcnt vmcnt(34)
    v_dot2_f32_bf16 v20, v72, v16, 0
    v_dot2_f32_bf16 v21, v76, v16, 0
    v_dot2_f32_bf16 v22, v80, v16, 0
    v_dot2_f32_bf16 v23, v84, v16, 0
    v_dot2c_f32_bf16 v20, v73, v17
    v_dot2c_f32_bf16 v21, v77, v17
    v_dot2c_f32_bf16 v22, v81, v17
    v_dot2c_f32_bf16 v23, v85, v17
    v_dot2c_f32_bf16 v20, v74, v18
    v_dot2c_f32_bf16 v21, v78, v18
    v_dot2c_f32_bf16 v22, v82, v18
    v_dot2c_f32_bf16 v23, v86, v18
    v_dot2c_f32_bf16 v20, v75, v19
    v_dot2c_f32_bf16 v21, v79, v19
    v_dot2c_f32_bf16 v22, v83, v19
    v_dot2c_f32_bf16 v23, v87, v19
    s_add_u32 m0, s49, 24576
    s_nop 0
    global_load_lds_dwordx4 v[34:35], off
    v_lshl_add_u64 v[34:35], s[38:39], 0, v[34:35]
    s_add_u32 s43, s43, 32768
    buffer_load_dwordx4 v[72:75], v1, s[4:7], s43 offen offset:0 sc0 sc1 nt
    buffer_load_dwordx4 v[76:79], v1, s[4:7], s43 offen offset:1024 sc0 sc1 nt
    buffer_load_dwordx4 v[80:83], v1, s[4:7], s43 offen offset:2048 sc0 sc1 nt
    buffer_load_dwordx4 v[84:87], v1, s[4:7], s43 offen offset:3072 sc0 sc1 nt
    v_add_f32_dpp v20, v20, v20 row_ror:8 row_mask:0xf bank_mask:0x3
    v_add_f32_dpp v22, v22, v22 row_ror:8 row_mask:0xf bank_mask:0x3
    s_nop 0
    v_add_f32_dpp v20, v21, v21 row_ror:8 row_mask:0xf bank_mask:0xc
    v_add_f32_dpp v22, v23, v23 row_ror:8 row_mask:0xf bank_mask:0xc
    s_nop 0
    v_add_f32_dpp v20, v20, v20 row_half_mirror row_mask:0xf bank_mask:0x5
    s_nop 1
    v_add_f32_dpp v20, v22, v22 row_half_mirror row_mask:0xf bank_mask:0xa
    s_nop 1
    v_add_f32_dpp v20, v20, v20 quad_perm:[1,0,3,2] row_mask:0xf bank_mask:0xf
    s_nop 1
    v_add_f32_dpp v20, v20, v20 quad_perm:[2,3,0,1] row_mask:0xf bank_mask:0xf
    v_cvt_pk_bf16_f32 v20, v20, v20
    v_and_b32 v20, s50, v20
    v_mul_f32 v20, s51, v20
    v_cvt_pk_bf16_f32 v20, v20, v20
    v_and_b32 v20, s50, v20
    s_nop 1
    v_max_f32_dpp v21, v20, v20 row_ror:4 row_mask:0xf bank_mask:0xf
    s_nop 1
    v_max_f32_dpp v21, v21, v21 row_ror:8 row_mask:0xf bank_mask:0xf
    v_max_f32 v21, v21, v5
    v_sub_f32 v22, v5, v21
    v_sub_f32 v20, v20, v21
    v_mov_b32 v5, v21
    v_mul_f32 v22, s52, v22
    v_mul_f32 v20, s52, v20
    v_exp_f32 v26, v22
    v_exp_f32 v20, v20
    v_pk_mul_f32 v[8:9], v[8:9], v[26:27] op_sel_hi:[1,0]
    v_pk_mul_f32 v[10:11], v[10:11], v[26:27] op_sel_hi:[1,0]
    v_pk_mul_f32 v[12:13], v[12:13], v[26:27] op_sel_hi:[1,0]
    v_pk_mul_f32 v[14:15], v[14:15], v[26:27] op_sel_hi:[1,0]
    v_cvt_pk_bf16_f32 v24, v20, 0
    v_cvt_pk_bf16_f32 v25, 0, v20
    v_fma_f32 v6, v6, v26, v20
    s_waitcnt vmcnt(35)
    v_dot2c_f32_bf16_dpp v8, v24, v88 row_newbcast:0 row_mask:0xf bank_mask:0xf
    v_dot2c_f32_bf16_dpp v9, v25, v88 row_newbcast:0 row_mask:0xf bank_mask:0xf
    v_dot2c_f32_bf16_dpp v10, v24, v89 row_newbcast:0 row_mask:0xf bank_mask:0xf
    v_dot2c_f32_bf16_dpp v11, v25, v89 row_newbcast:0 row_mask:0xf bank_mask:0xf
    v_dot2c_f32_bf16_dpp v12, v24, v90 row_newbcast:0 row_mask:0xf bank_mask:0xf
    v_dot2c_f32_bf16_dpp v13, v25, v90 row_newbcast:0 row_mask:0xf bank_mask:0xf
    v_dot2c_f32_bf16_dpp v14, v24, v91 row_newbcast:0 row_mask:0xf bank_mask:0xf
    v_dot2c_f32_bf16_dpp v15, v25, v91 row_newbcast:0 row_mask:0xf bank_mask:0xf
    v_dot2c_f32_bf16_dpp v8, v24, v92 row_newbcast:8 row_mask:0xf bank_mask:0xf
    v_dot2c_f32_bf16_dpp v9, v25, v92 row_newbcast:8 row_mask:0xf bank_mask:0xf
    v_dot2c_f32_bf16_dpp v10, v24, v93 row_newbcast:8 row_mask:0xf bank_mask:0xf
    v_dot2c_f32_bf16_dpp v11, v25, v93 row_newbcast:8 row_mask:0xf bank_mask:0xf
    v_dot2c_f32_bf16_dpp v12, v24, v94 row_newbcast:8 row_mask:0xf bank_mask:0xf
    v_dot2c_f32_bf16_dpp v13, v25, v94 row_newbcast:8 row_mask:0xf bank_mask:0xf
    v_dot2c_f32_bf16_dpp v14, v24, v95 row_newbcast:8 row_mask:0xf bank_mask:0xf
    v_dot2c_f32_bf16_dpp v15, v25, v95 row_newbcast:8 row_mask:0xf bank_mask:0xf
    v_dot2c_f32_bf16_dpp v8, v24, v96 row_newbcast:4 row_mask:0xf bank_mask:0xf
    v_dot2c_f32_bf16_dpp v9, v25, v96 row_newbcast:4 row_mask:0xf bank_mask:0xf
    v_dot2c_f32_bf16_dpp v10, v24, v97 row_newbcast:4 row_mask:0xf bank_mask:0xf
    v_dot2c_f32_bf16_dpp v11, v25, v97 row_newbcast:4 row_mask:0xf bank_mask:0xf
    v_dot2c_f32_bf16_dpp v12, v24, v98 row_newbcast:4 row_mask:0xf bank_mask:0xf
    v_dot2c_f32_bf16_dpp v13, v25, v98 row_newbcast:4 row_mask:0xf bank_mask:0xf
    v_dot2c_f32_bf16_dpp v14, v24, v99 row_newbcast:4 row_mask:0xf bank_mask:0xf
    v_dot2c_f32_bf16_dpp v15, v25, v99 row_newbcast:4 row_mask:0xf bank_mask:0xf
    v_dot2c_f32_bf16_dpp v8, v24, v100 row_newbcast:12 row_mask:0xf bank_mask:0xf
    v_dot2c_f32_bf16_dpp v9, v25, v100 row_newbcast:12 row_mask:0xf bank_mask:0xf
    v_dot2c_f32_bf16_dpp v10, v24, v101 row_newbcast:12 row_mask:0xf bank_mask:0xf
    v_dot2c_f32_bf16_dpp v11, v25, v101 row_newbcast:12 row_mask:0xf bank_mask:0xf
    v_dot2c_f32_bf16_dpp v12, v24, v102 row_newbcast:12 row_mask:0xf bank_mask:0xf
    v_dot2c_f32_bf16_dpp v13, v25, v102 row_newbcast:12 row_mask:0xf bank_mask:0xf
    v_dot2c_f32_bf16_dpp v14, v24, v103 row_newbcast:12 row_mask:0xf bank_mask:0xf
    v_dot2c_f32_bf16_dpp v15, v25, v103 row_newbcast:12 row_mask:0xf bank_mask:0xf
    s_add_u32 m0, s49, 32768
    s_nop 0
    global_load_lds_dwordx4 v[34:35], off
    v_lshl_add_u64 v[34:35], s[38:39], 0, v[34:35]
    buffer_load_dwordx4 v[88:91], v1, s[8:11], s43 offen offset:0 sc0 sc1 nt
    buffer_load_dwordx4 v[92:95], v1, s[8:11], s43 offen offset:1024 sc0 sc1 nt
    buffer_load_dwordx4 v[96:99], v1, s[8:11], s43 offen offset:2048 sc0 sc1 nt
    buffer_load_dwordx4 v[100:103], v1, s[8:11], s43 offen offset:3072 sc0 sc1 nt
    s_waitcnt vmcnt(35)
    v_dot2_f32_bf16 v20, v192, v16, 0
    v_dot2_f32_bf16 v21, v196, v16, 0
    v_dot2_f32_bf16 v22, v200, v16, 0
    v_dot2_f32_bf16 v23, v204, v16, 0
    v_dot2c_f32_bf16 v20, v193, v17
    v_dot2c_f32_bf16 v21, v197, v17
    v_dot2c_f32_bf16 v22, v201, v17
    v_dot2c_f32_bf16 v23, v205, v17
    v_dot2c_f32_bf16 v20, v194, v18
    v_dot2c_f32_bf16 v21, v198, v18
    v_dot2c_f32_bf16 v22, v202, v18
    v_dot2c_f32_bf16 v23, v206, v18
    v_dot2c_f32_bf16 v20, v195, v19
    v_dot2c_f32_bf16 v21, v199, v19
    v_dot2c_f32_bf16 v22, v203, v19
    v_dot2c_f32_bf16 v23, v207, v19
    s_add_u32 m0, s49, 40960
    s_nop 0
    global_load_lds_dwordx4 v[34:35], off
    v_lshl_add_u64 v[34:35], s[38:39], 0, v[34:35]
    s_add_u32 s43, s43, 32768
    buffer_load_dwordx4 v[192:195], v1, s[4:7], s43 offen offset:0 sc0 sc1 nt
    buffer_load_dwordx4 v[196:199], v1, s[4:7], s43 offen offset:1024 sc0 sc1 nt
    buffer_load_dwordx4 v[200:203], v1, s[4:7], s43 offen offset:2048 sc0 sc1 nt
    buffer_load_dwordx4 v[204:207], v1, s[4:7], s43 offen offset:3072 sc0 sc1 nt
    v_add_f32_dpp v20, v20, v20 row_ror:8 row_mask:0xf bank_mask:0x3
    v_add_f32_dpp v22, v22, v22 row_ror:8 row_mask:0xf bank_mask:0x3
    s_nop 0
    v_add_f32_dpp v20, v21, v21 row_ror:8 row_mask:0xf bank_mask:0xc
    v_add_f32_dpp v22, v23, v23 row_ror:8 row_mask:0xf bank_mask:0xc
    s_nop 0
    v_add_f32_dpp v20, v20, v20 row_half_mirror row_mask:0xf bank_mask:0x5
    s_nop 1
    v_add_f32_dpp v20, v22, v22 row_half_mirror row_mask:0xf bank_mask:0xa
    s_nop 1
    v_add_f32_dpp v20, v20, v20 quad_perm:[1,0,3,2] row_mask:0xf bank_mask:0xf
    s_nop 1
    v_add_f32_dpp v20, v20, v20 quad_perm:[2,3,0,1] row_mask:0xf bank_mask:0xf
    v_cvt_pk_bf16_f32 v20, v20, v20
    v_and_b32 v20, s50, v20
    v_mul_f32 v20, s51, v20
    v_cvt_pk_bf16_f32 v20, v20, v20
    v_and_b32 v20, s50, v20
    s_nop 1
    v_max_f32_dpp v21, v20, v20 row_ror:4 row_mask:0xf bank_mask:0xf
    s_nop 1
    v_max_f32_dpp v21, v21, v21 row_ror:8 row_mask:0xf bank_mask:0xf
    v_max_f32 v21, v21, v5
    v_sub_f32 v22, v5, v21
    v_sub_f32 v20, v20, v21
    v_mov_b32 v5, v21
    v_mul_f32 v22, s52, v22
    v_mul_f32 v20, s52, v20
    v_exp_f32 v26, v22
    v_exp_f32 v20, v20
    v_pk_mul_f32 v[8:9], v[8:9], v[26:27] op_sel_hi:[1,0]
    v_pk_mul_f32 v[10:11], v[10:11], v[26:27] op_sel_hi:[1,0]
    v_pk_mul_f32 v[12:13], v[12:13], v[26:27] op_sel_hi:[1,0]
    v_pk_mul_f32 v[14:15], v[14:15], v[26:27] op_sel_hi:[1,0]
    v_cvt_pk_bf16_f32 v24, v20, 0
    v_cvt_pk_bf16_f32 v25, 0, v20
    v_fma_f32 v6, v6, v26, v20
    s_waitcnt vmcnt(35)
    v_dot2c_f32_bf16_dpp v8, v24, v208 row_newbcast:0 row_mask:0xf bank_mask:0xf
    v_dot2c_f32_bf16_dpp v9, v25, v208 row_newbcast:0 row_mask:0xf bank_mask:0xf
    v_dot2c_f32_bf16_dpp v10, v24, v209 row_newbcast:0 row_mask:0xf bank_mask:0xf
    v_dot2c_f32_bf16_dpp v11, v25, v209 row_newbcast:0 row_mask:0xf bank_mask:0xf
    v_dot2c_f32_bf16_dpp v12, v24, v210 row_newbcast:0 row_mask:0xf bank_mask:0xf
    v_dot2c_f32_bf16_dpp v13, v25, v210 row_newbcast:0 row_mask:0xf bank_mask:0xf
    v_dot2c_f32_bf16_dpp v14, v24, v211 row_newbcast:0 row_mask:0xf bank_mask:0xf
    v_dot2c_f32_bf16_dpp v15, v25, v211 row_newbcast:0 row_mask:0xf bank_mask:0xf
    v_dot2c_f32_bf16_dpp v8, v24, v212 row_newbcast:8 row_mask:0xf bank_mask:0xf
    v_dot2c_f32_bf16_dpp v9, v25, v212 row_newbcast:8 row_mask:0xf bank_mask:0xf
    v_dot2c_f32_bf16_dpp v10, v24, v213 row_newbcast:8 row_mask:0xf bank_mask:0xf
    v_dot2c_f32_bf16_dpp v11, v25, v213 row_newbcast:8 row_mask:0xf bank_mask:0xf
    v_dot2c_f32_bf16_dpp v12, v24, v214 row_newbcast:8 row_mask:0xf bank_mask:0xf
    v_dot2c_f32_bf16_dpp v13, v25, v214 row_newbcast:8 row_mask:0xf bank_mask:0xf
    v_dot2c_f32_bf16_dpp v14, v24, v215 row_newbcast:8 row_mask:0xf bank_mask:0xf
    v_dot2c_f32_bf16_dpp v15, v25, v215 row_newbcast:8 row_mask:0xf bank_mask:0xf
    v_dot2c_f32_bf16_dpp v8, v24, v216 row_newbcast:4 row_mask:0xf bank_mask:0xf
    v_dot2c_f32_bf16_dpp v9, v25, v216 row_newbcast:4 row_mask:0xf bank_mask:0xf
    v_dot2c_f32_bf16_dpp v10, v24, v217 row_newbcast:4 row_mask:0xf bank_mask:0xf
    v_dot2c_f32_bf16_dpp v11, v25, v217 row_newbcast:4 row_mask:0xf bank_mask:0xf
    v_dot2c_f32_bf16_dpp v12, v24, v218 row_newbcast:4 row_mask:0xf bank_mask:0xf
    v_dot2c_f32_bf16_dpp v13, v25, v218 row_newbcast:4 row_mask:0xf bank_mask:0xf
    v_dot2c_f32_bf16_dpp v14, v24, v219 row_newbcast:4 row_mask:0xf bank_mask:0xf
    v_dot2c_f32_bf16_dpp v15, v25, v219 row_newbcast:4 row_mask:0xf bank_mask:0xf
    v_dot2c_f32_bf16_dpp v8, v24, v220 row_newbcast:12 row_mask:0xf bank_mask:0xf
    v_dot2c_f32_bf16_dpp v9, v25, v220 row_newbcast:12 row_mask:0xf bank_mask:0xf
    v_dot2c_f32_bf16_dpp v10, v24, v221 row_newbcast:12 row_mask:0xf bank_mask:0xf
    v_dot2c_f32_bf16_dpp v11, v25, v221 row_newbcast:12 row_mask:0xf bank_mask:0xf
    v_dot2c_f32_bf16_dpp v12, v24, v222 row_newbcast:12 row_mask:0xf bank_mask:0xf
    v_dot2c_f32_bf16_dpp v13, v25, v222 row_newbcast:12 row_mask:0xf bank_mask:0xf
    v_dot2c_f32_bf16_dpp v14, v24, v223 row_newbcast:12 row_mask:0xf bank_mask:0xf
    v_dot2c_f32_bf16_dpp v15, v25, v223 row_newbcast:12 row_mask:0xf bank_mask:0xf
    s_add_u32 m0, s49, 49152
    s_nop 0
    global_load_lds_dwordx4 v[34:35], off
    v_lshl_add_u64 v[34:35], s[38:39], 0, v[34:35]
    buffer_load_dwordx4 v[208:211], v1, s[8:11], s43 offen offset:0 sc0 sc1 nt
    buffer_load_dwordx4 v[212:215], v1, s[8:11], s43 offen offset:1024 sc0 sc1 nt
    buffer_load_dwordx4 v[216:219], v1, s[8:11], s43 offen offset:2048 sc0 sc1 nt
    buffer_load_dwordx4 v[220:223], v1, s[8:11], s43 offen offset:3072 sc0 sc1 nt
    s_waitcnt vmcnt(35)
    v_dot2_f32_bf16 v20, v224, v16, 0
    v_dot2_f32_bf16 v21, v228, v16, 0
    v_dot2_f32_bf16 v22, v232, v16, 0
    v_dot2_f32_bf16 v23, v236, v16, 0
    v_dot2c_f32_bf16 v20, v225, v17
    v_dot2c_f32_bf16 v21, v229, v17
    v_dot2c_f32_bf16 v22, v233, v17
    v_dot2c_f32_bf16 v23, v237, v17
    v_dot2c_f32_bf16 v20, v226, v18
    v_dot2c_f32_bf16 v21, v230, v18
    v_dot2c_f32_bf16 v22, v234, v18
    v_dot2c_f32_bf16 v23, v238, v18
    v_dot2c_f32_bf16 v20, v227, v19
    v_dot2c_f32_bf16 v21, v231, v19
    v_dot2c_f32_bf16 v22, v235, v19
    v_dot2c_f32_bf16 v23, v239, v19
    s_add_u32 m0, s49, 57344
    s_nop 0
    global_load_lds_dwordx4 v[34:35], off
    v_lshl_add_u64 v[34:35], s[38:39], 0, v[34:35]
    s_add_u32 s43, s43, 32768
    buffer_load_dwordx4 v[224:227], v1, s[4:7], s43 offen offset:0 sc0 sc1 nt
    buffer_load_dwordx4 v[228:231], v1, s[4:7], s43 offen offset:1024 sc0 sc1 nt
    buffer_load_dwordx4 v[232:235], v1, s[4:7], s43 offen offset:2048 sc0 sc1 nt
    buffer_load_dwordx4 v[236:239], v1, s[4:7], s43 offen offset:3072 sc0 sc1 nt
    v_add_f32_dpp v20, v20, v20 row_ror:8 row_mask:0xf bank_mask:0x3
    v_add_f32_dpp v22, v22, v22 row_ror:8 row_mask:0xf bank_mask:0x3
    s_nop 0
    v_add_f32_dpp v20, v21, v21 row_ror:8 row_mask:0xf bank_mask:0xc
    v_add_f32_dpp v22, v23, v23 row_ror:8 row_mask:0xf bank_mask:0xc
    s_nop 0
    v_add_f32_dpp v20, v20, v20 row_half_mirror row_mask:0xf bank_mask:0x5
    s_nop 1
    v_add_f32_dpp v20, v22, v22 row_half_mirror row_mask:0xf bank_mask:0xa
    s_nop 1
    v_add_f32_dpp v20, v20, v20 quad_perm:[1,0,3,2] row_mask:0xf bank_mask:0xf
    s_nop 1
    v_add_f32_dpp v20, v20, v20 quad_perm:[2,3,0,1] row_mask:0xf bank_mask:0xf
    v_cvt_pk_bf16_f32 v20, v20, v20
    v_and_b32 v20, s50, v20
    v_mul_f32 v20, s51, v20
    v_cvt_pk_bf16_f32 v20, v20, v20
    v_and_b32 v20, s50, v20
    s_nop 1
    v_max_f32_dpp v21, v20, v20 row_ror:4 row_mask:0xf bank_mask:0xf
    s_nop 1
    v_max_f32_dpp v21, v21, v21 row_ror:8 row_mask:0xf bank_mask:0xf
    v_max_f32 v21, v21, v5
    v_sub_f32 v22, v5, v21
    v_sub_f32 v20, v20, v21
    v_mov_b32 v5, v21
    v_mul_f32 v22, s52, v22
    v_mul_f32 v20, s52, v20
    v_exp_f32 v26, v22
    v_exp_f32 v20, v20
    v_pk_mul_f32 v[8:9], v[8:9], v[26:27] op_sel_hi:[1,0]
    v_pk_mul_f32 v[10:11], v[10:11], v[26:27] op_sel_hi:[1,0]
    v_pk_mul_f32 v[12:13], v[12:13], v[26:27] op_sel_hi:[1,0]
    v_pk_mul_f32 v[14:15], v[14:15], v[26:27] op_sel_hi:[1,0]
    v_cvt_pk_bf16_f32 v24, v20, 0
    v_cvt_pk_bf16_f32 v25, 0, v20
    v_fma_f32 v6, v6, v26, v20
    s_waitcnt vmcnt(35)
    v_dot2c_f32_bf16_dpp v8, v24, v240 row_newbcast:0 row_mask:0xf bank_mask:0xf
    v_dot2c_f32_bf16_dpp v9, v25, v240 row_newbcast:0 row_mask:0xf bank_mask:0xf
    v_dot2c_f32_bf16_dpp v10, v24, v241 row_newbcast:0 row_mask:0xf bank_mask:0xf
    v_dot2c_f32_bf16_dpp v11, v25, v241 row_newbcast:0 row_mask:0xf bank_mask:0xf
    v_dot2c_f32_bf16_dpp v12, v24, v242 row_newbcast:0 row_mask:0xf bank_mask:0xf
    v_dot2c_f32_bf16_dpp v13, v25, v242 row_newbcast:0 row_mask:0xf bank_mask:0xf
    v_dot2c_f32_bf16_dpp v14, v24, v243 row_newbcast:0 row_mask:0xf bank_mask:0xf
    v_dot2c_f32_bf16_dpp v15, v25, v243 row_newbcast:0 row_mask:0xf bank_mask:0xf
    v_dot2c_f32_bf16_dpp v8, v24, v244 row_newbcast:8 row_mask:0xf bank_mask:0xf
    v_dot2c_f32_bf16_dpp v9, v25, v244 row_newbcast:8 row_mask:0xf bank_mask:0xf
    v_dot2c_f32_bf16_dpp v10, v24, v245 row_newbcast:8 row_mask:0xf bank_mask:0xf
    v_dot2c_f32_bf16_dpp v11, v25, v245 row_newbcast:8 row_mask:0xf bank_mask:0xf
    v_dot2c_f32_bf16_dpp v12, v24, v246 row_newbcast:8 row_mask:0xf bank_mask:0xf
    v_dot2c_f32_bf16_dpp v13, v25, v246 row_newbcast:8 row_mask:0xf bank_mask:0xf
    v_dot2c_f32_bf16_dpp v14, v24, v247 row_newbcast:8 row_mask:0xf bank_mask:0xf
    v_dot2c_f32_bf16_dpp v15, v25, v247 row_newbcast:8 row_mask:0xf bank_mask:0xf
    v_dot2c_f32_bf16_dpp v8, v24, v248 row_newbcast:4 row_mask:0xf bank_mask:0xf
    v_dot2c_f32_bf16_dpp v9, v25, v248 row_newbcast:4 row_mask:0xf bank_mask:0xf
    v_dot2c_f32_bf16_dpp v10, v24, v249 row_newbcast:4 row_mask:0xf bank_mask:0xf
    v_dot2c_f32_bf16_dpp v11, v25, v249 row_newbcast:4 row_mask:0xf bank_mask:0xf
    v_dot2c_f32_bf16_dpp v12, v24, v250 row_newbcast:4 row_mask:0xf bank_mask:0xf
    v_dot2c_f32_bf16_dpp v13, v25, v250 row_newbcast:4 row_mask:0xf bank_mask:0xf
    v_dot2c_f32_bf16_dpp v14, v24, v251 row_newbcast:4 row_mask:0xf bank_mask:0xf
    v_dot2c_f32_bf16_dpp v15, v25, v251 row_newbcast:4 row_mask:0xf bank_mask:0xf
    v_dot2c_f32_bf16_dpp v8, v24, v252 row_newbcast:12 row_mask:0xf bank_mask:0xf
    v_dot2c_f32_bf16_dpp v9, v25, v252 row_newbcast:12 row_mask:0xf bank_mask:0xf
    v_dot2c_f32_bf16_dpp v10, v24, v253 row_newbcast:12 row_mask:0xf bank_mask:0xf
    v_dot2c_f32_bf16_dpp v11, v25, v253 row_newbcast:12 row_mask:0xf bank_mask:0xf
    v_dot2c_f32_bf16_dpp v12, v24, v254 row_newbcast:12 row_mask:0xf bank_mask:0xf
    v_dot2c_f32_bf16_dpp v13, v25, v254 row_newbcast:12 row_mask:0xf bank_mask:0xf
    v_dot2c_f32_bf16_dpp v14, v24, v255 row_newbcast:12 row_mask:0xf bank_mask:0xf
    v_dot2c_f32_bf16_dpp v15, v25, v255 row_newbcast:12 row_mask:0xf bank_mask:0xf
    s_add_u32 m0, s49, 65536
    s_nop 0
    global_load_lds_dwordx4 v[34:35], off
    v_lshl_add_u64 v[34:35], s[38:39], 0, v[34:35]
    buffer_load_dwordx4 v[240:243], v1, s[8:11], s43 offen offset:0 sc0 sc1 nt
    buffer_load_dwordx4 v[244:247], v1, s[8:11], s43 offen offset:1024 sc0 sc1 nt
    buffer_load_dwordx4 v[248:251], v1, s[8:11], s43 offen offset:2048 sc0 sc1 nt
    buffer_load_dwordx4 v[252:255], v1, s[8:11], s43 offen offset:3072 sc0 sc1 nt
    v_perm_b32 v23, v108, v104, s53
    v_perm_b32 v108, v108, v104, s54
    v_perm_b32 v104, v109, v105, s53
    v_perm_b32 v109, v109, v105, s54
    v_perm_b32 v105, v110, v106, s53
    v_perm_b32 v110, v110, v106, s54
    v_perm_b32 v106, v111, v107, s53
    v_perm_b32 v111, v111, v107, s54
    v_perm_b32 v107, v116, v112, s53
    v_perm_b32 v116, v116, v112, s54
    v_perm_b32 v112, v117, v113, s53
    v_perm_b32 v117, v117, v113, s54
    v_perm_b32 v113, v118, v114, s53
    v_perm_b32 v118, v118, v114, s54
    v_perm_b32 v114, v119, v115, s53
    v_perm_b32 v119, v119, v115, s54
    v_perm_b32 v115, v124, v120, s53
    v_perm_b32 v124, v124, v120, s54
    v_perm_b32 v120, v125, v121, s53
    v_perm_b32 v125, v125, v121, s54
    v_perm_b32 v121, v126, v122, s53
    v_perm_b32 v126, v126, v122, s54
    v_perm_b32 v122, v127, v123, s53
    v_perm_b32 v127, v127, v123, s54
    v_perm_b32 v123, v132, v128, s53
    v_perm_b32 v132, v132, v128, s54
    v_perm_b32 v128, v133, v129, s53
    v_perm_b32 v133, v133, v129, s54
    v_perm_b32 v129, v134, v130, s53
    v_perm_b32 v134, v134, v130, s54
    v_perm_b32 v130, v135, v131, s53
    v_perm_b32 v135, v135, v131, s54
    v_perm_b32 v131, v140, v136, s53
    v_perm_b32 v140, v140, v136, s54
    v_perm_b32 v136, v141, v137, s53
    v_perm_b32 v141, v141, v137, s54
    v_perm_b32 v137, v142, v138, s53
    v_perm_b32 v142, v142, v138, s54
    v_perm_b32 v138, v143, v139, s53
    v_perm_b32 v143, v143, v139, s54
    v_perm_b32 v139, v148, v144, s53
    v_perm_b32 v148, v148, v144, s54
    v_perm_b32 v144, v149, v145, s53
    v_perm_b32 v149, v149, v145, s54
    v_perm_b32 v145, v150, v146, s53
    v_perm_b32 v150, v150, v146, s54
    v_perm_b32 v146, v151, v147, s53
    v_perm_b32 v151, v151, v147, s54
    v_perm_b32 v147, v156, v152, s53
    v_perm_b32 v156, v156, v152, s54
    v_perm_b32 v152, v157, v153, s53
    v_perm_b32 v157, v157, v153, s54
    v_perm_b32 v153, v158, v154, s53
    v_perm_b32 v158, v158, v154, s54
    v_perm_b32 v154, v159, v155, s53
    v_perm_b32 v159, v159, v155, s54
    v_perm_b32 v155, v164, v160, s53
    v_perm_b32 v164, v164, v160, s54
    v_perm_b32 v160, v165, v161, s53
    v_perm_b32 v165, v165, v161, s54
    v_perm_b32 v161, v166, v162, s53
    v_perm_b32 v166, v166, v162, s54
    v_perm_b32 v162, v167, v163, s53
    v_perm_b32 v167, v167, v163, s54
    v_perm_b32 v163, v172, v168, s53
    v_perm_b32 v172, v172, v168, s54
    v_perm_b32 v168, v173, v169, s53
    v_perm_b32 v173, v173, v169, s54
    v_perm_b32 v169, v174, v170, s53
    v_perm_b32 v174, v174, v170, s54
    v_perm_b32 v170, v175, v171, s53
    v_perm_b32 v175, v175, v171, s54
    v_perm_b32 v171, v180, v176, s53
    v_perm_b32 v180, v180, v176, s54
    v_perm_b32 v176, v181, v177, s53
    v_perm_b32 v181, v181, v177, s54
    v_perm_b32 v177, v182, v178, s53
    v_perm_b32 v182, v182, v178, s54
    v_perm_b32 v178, v183, v179, s53
    v_perm_b32 v183, v183, v179, s54
    v_perm_b32 v179, v188, v184, s53
    v_perm_b32 v188, v188, v184, s54
    v_perm_b32 v184, v189, v185, s53
    v_perm_b32 v189, v189, v185, s54
    v_perm_b32 v185, v190, v186, s53
    v_perm_b32 v190, v190, v186, s54
    v_perm_b32 v186, v191, v187, s53
    v_perm_b32 v191, v191, v187, s54
    v_mov_b32 v187, v23
    s_setprio 1
    s_waitcnt vmcnt(35)
    v_dot2_f32_bf16 v20, v40, v16, 0
    v_dot2_f32_bf16 v21, v44, v16, 0
    v_dot2_f32_bf16 v22, v48, v16, 0
    v_dot2_f32_bf16 v23, v52, v16, 0
    v_dot2c_f32_bf16 v20, v41, v17
    v_dot2c_f32_bf16 v21, v45, v17
    v_dot2c_f32_bf16 v22, v49, v17
    v_dot2c_f32_bf16 v23, v53, v17
    v_dot2c_f32_bf16 v20, v42, v18
    v_dot2c_f32_bf16 v21, v46, v18
    v_dot2c_f32_bf16 v22, v50, v18
    v_dot2c_f32_bf16 v23, v54, v18
    v_dot2c_f32_bf16 v20, v43, v19
    v_dot2c_f32_bf16 v21, v47, v19
    v_dot2c_f32_bf16 v22, v51, v19
    v_dot2c_f32_bf16 v23, v55, v19
    s_add_u32 m0, s49, 73728
    s_nop 0
    global_load_lds_dwordx4 v[34:35], off
    v_lshl_add_u64 v[34:35], s[38:39], 0, v[34:35]
    s_add_u32 s43, s43, 32768
    buffer_load_dwordx4 v[40:43], v1, s[4:7], s43 offen offset:0 sc0 sc1 nt
    buffer_load_dwordx4 v[44:47], v1, s[4:7], s43 offen offset:1024 sc0 sc1 nt
    buffer_load_dwordx4 v[48:51], v1, s[4:7], s43 offen offset:2048 sc0 sc1 nt
    buffer_load_dwordx4 v[52:55], v1, s[4:7], s43 offen offset:3072 sc0 sc1 nt
    v_add_f32_dpp v20, v20, v20 row_ror:8 row_mask:0xf bank_mask:0x3
    v_add_f32_dpp v22, v22, v22 row_ror:8 row_mask:0xf bank_mask:0x3
    s_nop 0
    v_add_f32_dpp v20, v21, v21 row_ror:8 row_mask:0xf bank_mask:0xc
    v_add_f32_dpp v22, v23, v23 row_ror:8 row_mask:0xf bank_mask:0xc
    s_nop 0
    v_add_f32_dpp v20, v20, v20 row_half_mirror row_mask:0xf bank_mask:0x5
    s_nop 1
    v_add_f32_dpp v20, v22, v22 row_half_mirror row_mask:0xf bank_mask:0xa
    s_nop 1
    v_add_f32_dpp v20, v20, v20 quad_perm:[1,0,3,2] row_mask:0xf bank_mask:0xf
    s_nop 1
    v_add_f32_dpp v20, v20, v20 quad_perm:[2,3,0,1] row_mask:0xf bank_mask:0xf
    v_cvt_pk_bf16_f32 v20, v20, v20
    v_and_b32 v20, s50, v20
    v_mul_f32 v20, s51, v20
    v_cvt_pk_bf16_f32 v20, v20, v20
    v_and_b32 v20, s50, v20
    s_nop 1
    v_max_f32_dpp v21, v20, v20 row_ror:4 row_mask:0xf bank_mask:0xf
    s_nop 1
    v_max_f32_dpp v21, v21, v21 row_ror:8 row_mask:0xf bank_mask:0xf
    v_max_f32 v21, v21, v5
    v_sub_f32 v22, v5, v21
    v_sub_f32 v20, v20, v21
    v_mov_b32 v5, v21
    v_mul_f32 v22, s52, v22
    v_mul_f32 v20, s52, v20
    v_exp_f32 v26, v22
    v_exp_f32 v20, v20
    v_pk_mul_f32 v[8:9], v[8:9], v[26:27] op_sel_hi:[1,0]
    v_pk_mul_f32 v[10:11], v[10:11], v[26:27] op_sel_hi:[1,0]
    v_pk_mul_f32 v[12:13], v[12:13], v[26:27] op_sel_hi:[1,0]
    v_pk_mul_f32 v[14:15], v[14:15], v[26:27] op_sel_hi:[1,0]
    v_cvt_pk_bf16_f32 v24, v20, 0
    v_cvt_pk_bf16_f32 v25, 0, v20
    v_fma_f32 v6, v6, v26, v20
    s_waitcnt vmcnt(35)
    v_dot2c_f32_bf16_dpp v8, v24, v56 row_newbcast:0 row_mask:0xf bank_mask:0xf
    v_dot2c_f32_bf16_dpp v9, v25, v56 row_newbcast:0 row_mask:0xf bank_mask:0xf
    v_dot2c_f32_bf16_dpp v10, v24, v57 row_newbcast:0 row_mask:0xf bank_mask:0xf
    v_dot2c_f32_bf16_dpp v11, v25, v57 row_newbcast:0 row_mask:0xf bank_mask:0xf
    v_dot2c_f32_bf16_dpp v12, v24, v58 row_newbcast:0 row_mask:0xf bank_mask:0xf
    v_dot2c_f32_bf16_dpp v13, v25, v58 row_newbcast:0 row_mask:0xf bank_mask:0xf
    v_dot2c_f32_bf16_dpp v14, v24, v59 row_newbcast:0 row_mask:0xf bank_mask:0xf
    v_dot2c_f32_bf16_dpp v15, v25, v59 row_newbcast:0 row_mask:0xf bank_mask:0xf
    v_dot2c_f32_bf16_dpp v8, v24, v60 row_newbcast:8 row_mask:0xf bank_mask:0xf
    v_dot2c_f32_bf16_dpp v9, v25, v60 row_newbcast:8 row_mask:0xf bank_mask:0xf
    v_dot2c_f32_bf16_dpp v10, v24, v61 row_newbcast:8 row_mask:0xf bank_mask:0xf
    v_dot2c_f32_bf16_dpp v11, v25, v61 row_newbcast:8 row_mask:0xf bank_mask:0xf
    v_dot2c_f32_bf16_dpp v12, v24, v62 row_newbcast:8 row_mask:0xf bank_mask:0xf
    v_dot2c_f32_bf16_dpp v13, v25, v62 row_newbcast:8 row_mask:0xf bank_mask:0xf
    v_dot2c_f32_bf16_dpp v14, v24, v63 row_newbcast:8 row_mask:0xf bank_mask:0xf
    v_dot2c_f32_bf16_dpp v15, v25, v63 row_newbcast:8 row_mask:0xf bank_mask:0xf
    v_dot2c_f32_bf16_dpp v8, v24, v64 row_newbcast:4 row_mask:0xf bank_mask:0xf
    v_dot2c_f32_bf16_dpp v9, v25, v64 row_newbcast:4 row_mask:0xf bank_mask:0xf
    v_dot2c_f32_bf16_dpp v10, v24, v65 row_newbcast:4 row_mask:0xf bank_mask:0xf
    v_dot2c_f32_bf16_dpp v11, v25, v65 row_newbcast:4 row_mask:0xf bank_mask:0xf
    v_dot2c_f32_bf16_dpp v12, v24, v66 row_newbcast:4 row_mask:0xf bank_mask:0xf
    v_dot2c_f32_bf16_dpp v13, v25, v66 row_newbcast:4 row_mask:0xf bank_mask:0xf
    v_dot2c_f32_bf16_dpp v14, v24, v67 row_newbcast:4 row_mask:0xf bank_mask:0xf
    v_dot2c_f32_bf16_dpp v15, v25, v67 row_newbcast:4 row_mask:0xf bank_mask:0xf
    v_dot2c_f32_bf16_dpp v8, v24, v68 row_newbcast:12 row_mask:0xf bank_mask:0xf
    v_dot2c_f32_bf16_dpp v9, v25, v68 row_newbcast:12 row_mask:0xf bank_mask:0xf
    v_dot2c_f32_bf16_dpp v10, v24, v69 row_newbcast:12 row_mask:0xf bank_mask:0xf
    v_dot2c_f32_bf16_dpp v11, v25, v69 row_newbcast:12 row_mask:0xf bank_mask:0xf
    v_dot2c_f32_bf16_dpp v12, v24, v70 row_newbcast:12 row_mask:0xf bank_mask:0xf
    v_dot2c_f32_bf16_dpp v13, v25, v70 row_newbcast:12 row_mask:0xf bank_mask:0xf
    v_dot2c_f32_bf16_dpp v14, v24, v71 row_newbcast:12 row_mask:0xf bank_mask:0xf
    v_dot2c_f32_bf16_dpp v15, v25, v71 row_newbcast:12 row_mask:0xf bank_mask:0xf
    s_add_u32 m0, s49, 81920
    s_nop 0
    global_load_lds_dwordx4 v[34:35], off
    v_lshl_add_u64 v[34:35], s[38:39], 0, v[34:35]
    buffer_load_dwordx4 v[56:59], v1, s[8:11], s43 offen offset:0 sc0 sc1 nt
    buffer_load_dwordx4 v[60:63], v1, s[8:11], s43 offen offset:1024 sc0 sc1 nt
    buffer_load_dwordx4 v[64:67], v1, s[8:11], s43 offen offset:2048 sc0 sc1 nt
    buffer_load_dwordx4 v[68:71], v1, s[8:11], s43 offen offset:3072 sc0 sc1 nt
    s_waitcnt vmcnt(35)
    v_dot2_f32_bf16 v20, v72, v16, 0
    v_dot2_f32_bf16 v21, v76, v16, 0
    v_dot2_f32_bf16 v22, v80, v16, 0
    v_dot2_f32_bf16 v23, v84, v16, 0
    v_dot2c_f32_bf16 v20, v73, v17
    v_dot2c_f32_bf16 v21, v77, v17
    v_dot2c_f32_bf16 v22, v81, v17
    v_dot2c_f32_bf16 v23, v85, v17
    v_dot2c_f32_bf16 v20, v74, v18
    v_dot2c_f32_bf16 v21, v78, v18
    v_dot2c_f32_bf16 v22, v82, v18
    v_dot2c_f32_bf16 v23, v86, v18
    v_dot2c_f32_bf16 v20, v75, v19
    v_dot2c_f32_bf16 v21, v79, v19
    v_dot2c_f32_bf16 v22, v83, v19
    v_dot2c_f32_bf16 v23, v87, v19
    s_add_u32 m0, s49, 90112
    s_nop 0
    global_load_lds_dwordx4 v[34:35], off
    v_lshl_add_u64 v[34:35], s[38:39], 0, v[34:35]
    s_add_u32 s43, s43, 32768
    buffer_load_dwordx4 v[72:75], v1, s[4:7], s43 offen offset:0 sc0 sc1 nt
    buffer_load_dwordx4 v[76:79], v1, s[4:7], s43 offen offset:1024 sc0 sc1 nt
    buffer_load_dwordx4 v[80:83], v1, s[4:7], s43 offen offset:2048 sc0 sc1 nt
    buffer_load_dwordx4 v[84:87], v1, s[4:7], s43 offen offset:3072 sc0 sc1 nt
    v_add_f32_dpp v20, v20, v20 row_ror:8 row_mask:0xf bank_mask:0x3
    v_add_f32_dpp v22, v22, v22 row_ror:8 row_mask:0xf bank_mask:0x3
    s_nop 0
    v_add_f32_dpp v20, v21, v21 row_ror:8 row_mask:0xf bank_mask:0xc
    v_add_f32_dpp v22, v23, v23 row_ror:8 row_mask:0xf bank_mask:0xc
    s_nop 0
    v_add_f32_dpp v20, v20, v20 row_half_mirror row_mask:0xf bank_mask:0x5
    s_nop 1
    v_add_f32_dpp v20, v22, v22 row_half_mirror row_mask:0xf bank_mask:0xa
    s_nop 1
    v_add_f32_dpp v20, v20, v20 quad_perm:[1,0,3,2] row_mask:0xf bank_mask:0xf
    s_nop 1
    v_add_f32_dpp v20, v20, v20 quad_perm:[2,3,0,1] row_mask:0xf bank_mask:0xf
    v_cvt_pk_bf16_f32 v20, v20, v20
    v_and_b32 v20, s50, v20
    v_mul_f32 v20, s51, v20
    v_cvt_pk_bf16_f32 v20, v20, v20
    v_and_b32 v20, s50, v20
    s_nop 1
    v_max_f32_dpp v21, v20, v20 row_ror:4 row_mask:0xf bank_mask:0xf
    s_nop 1
    v_max_f32_dpp v21, v21, v21 row_ror:8 row_mask:0xf bank_mask:0xf
    v_max_f32 v21, v21, v5
    v_sub_f32 v22, v5, v21
    v_sub_f32 v20, v20, v21
    v_mov_b32 v5, v21
    v_mul_f32 v22, s52, v22
    v_mul_f32 v20, s52, v20
    v_exp_f32 v26, v22
    v_exp_f32 v20, v20
    v_pk_mul_f32 v[8:9], v[8:9], v[26:27] op_sel_hi:[1,0]
    v_pk_mul_f32 v[10:11], v[10:11], v[26:27] op_sel_hi:[1,0]
    v_pk_mul_f32 v[12:13], v[12:13], v[26:27] op_sel_hi:[1,0]
    v_pk_mul_f32 v[14:15], v[14:15], v[26:27] op_sel_hi:[1,0]
    v_cvt_pk_bf16_f32 v24, v20, 0
    v_cvt_pk_bf16_f32 v25, 0, v20
    v_fma_f32 v6, v6, v26, v20
    s_waitcnt vmcnt(35)
    v_dot2c_f32_bf16_dpp v8, v24, v88 row_newbcast:0 row_mask:0xf bank_mask:0xf
    v_dot2c_f32_bf16_dpp v9, v25, v88 row_newbcast:0 row_mask:0xf bank_mask:0xf
    v_dot2c_f32_bf16_dpp v10, v24, v89 row_newbcast:0 row_mask:0xf bank_mask:0xf
    v_dot2c_f32_bf16_dpp v11, v25, v89 row_newbcast:0 row_mask:0xf bank_mask:0xf
    v_dot2c_f32_bf16_dpp v12, v24, v90 row_newbcast:0 row_mask:0xf bank_mask:0xf
    v_dot2c_f32_bf16_dpp v13, v25, v90 row_newbcast:0 row_mask:0xf bank_mask:0xf
    v_dot2c_f32_bf16_dpp v14, v24, v91 row_newbcast:0 row_mask:0xf bank_mask:0xf
    v_dot2c_f32_bf16_dpp v15, v25, v91 row_newbcast:0 row_mask:0xf bank_mask:0xf
    v_dot2c_f32_bf16_dpp v8, v24, v92 row_newbcast:8 row_mask:0xf bank_mask:0xf
    v_dot2c_f32_bf16_dpp v9, v25, v92 row_newbcast:8 row_mask:0xf bank_mask:0xf
    v_dot2c_f32_bf16_dpp v10, v24, v93 row_newbcast:8 row_mask:0xf bank_mask:0xf
    v_dot2c_f32_bf16_dpp v11, v25, v93 row_newbcast:8 row_mask:0xf bank_mask:0xf
    v_dot2c_f32_bf16_dpp v12, v24, v94 row_newbcast:8 row_mask:0xf bank_mask:0xf
    v_dot2c_f32_bf16_dpp v13, v25, v94 row_newbcast:8 row_mask:0xf bank_mask:0xf
    v_dot2c_f32_bf16_dpp v14, v24, v95 row_newbcast:8 row_mask:0xf bank_mask:0xf
    v_dot2c_f32_bf16_dpp v15, v25, v95 row_newbcast:8 row_mask:0xf bank_mask:0xf
    v_dot2c_f32_bf16_dpp v8, v24, v96 row_newbcast:4 row_mask:0xf bank_mask:0xf
    v_dot2c_f32_bf16_dpp v9, v25, v96 row_newbcast:4 row_mask:0xf bank_mask:0xf
    v_dot2c_f32_bf16_dpp v10, v24, v97 row_newbcast:4 row_mask:0xf bank_mask:0xf
    v_dot2c_f32_bf16_dpp v11, v25, v97 row_newbcast:4 row_mask:0xf bank_mask:0xf
    v_dot2c_f32_bf16_dpp v12, v24, v98 row_newbcast:4 row_mask:0xf bank_mask:0xf
    v_dot2c_f32_bf16_dpp v13, v25, v98 row_newbcast:4 row_mask:0xf bank_mask:0xf
    v_dot2c_f32_bf16_dpp v14, v24, v99 row_newbcast:4 row_mask:0xf bank_mask:0xf
    v_dot2c_f32_bf16_dpp v15, v25, v99 row_newbcast:4 row_mask:0xf bank_mask:0xf
    v_dot2c_f32_bf16_dpp v8, v24, v100 row_newbcast:12 row_mask:0xf bank_mask:0xf
    v_dot2c_f32_bf16_dpp v9, v25, v100 row_newbcast:12 row_mask:0xf bank_mask:0xf
    v_dot2c_f32_bf16_dpp v10, v24, v101 row_newbcast:12 row_mask:0xf bank_mask:0xf
    v_dot2c_f32_bf16_dpp v11, v25, v101 row_newbcast:12 row_mask:0xf bank_mask:0xf
    v_dot2c_f32_bf16_dpp v12, v24, v102 row_newbcast:12 row_mask:0xf bank_mask:0xf
    v_dot2c_f32_bf16_dpp v13, v25, v102 row_newbcast:12 row_mask:0xf bank_mask:0xf
    v_dot2c_f32_bf16_dpp v14, v24, v103 row_newbcast:12 row_mask:0xf bank_mask:0xf
    v_dot2c_f32_bf16_dpp v15, v25, v103 row_newbcast:12 row_mask:0xf bank_mask:0xf
    s_add_u32 m0, s49, 98304
    s_nop 0
    global_load_lds_dwordx4 v[34:35], off
    v_lshl_add_u64 v[34:35], s[38:39], 0, v[34:35]
    buffer_load_dwordx4 v[88:91], v1, s[8:11], s43 offen offset:0 sc0 sc1 nt
    buffer_load_dwordx4 v[92:95], v1, s[8:11], s43 offen offset:1024 sc0 sc1 nt
    buffer_load_dwordx4 v[96:99], v1, s[8:11], s43 offen offset:2048 sc0 sc1 nt
    buffer_load_dwordx4 v[100:103], v1, s[8:11], s43 offen offset:3072 sc0 sc1 nt
    s_waitcnt vmcnt(35)
    v_dot2_f32_bf16 v20, v192, v16, 0
    v_dot2_f32_bf16 v21, v196, v16, 0
    v_dot2_f32_bf16 v22, v200, v16, 0
    v_dot2_f32_bf16 v23, v204, v16, 0
    v_dot2c_f32_bf16 v20, v193, v17
    v_dot2c_f32_bf16 v21, v197, v17
    v_dot2c_f32_bf16 v22, v201, v17
    v_dot2c_f32_bf16 v23, v205, v17
    v_dot2c_f32_bf16 v20, v194, v18
    v_dot2c_f32_bf16 v21, v198, v18
    v_dot2c_f32_bf16 v22, v202, v18
    v_dot2c_f32_bf16 v23, v206, v18
    v_dot2c_f32_bf16 v20, v195, v19
    v_dot2c_f32_bf16 v21, v199, v19
    v_dot2c_f32_bf16 v22, v203, v19
    v_dot2c_f32_bf16 v23, v207, v19
    s_add_u32 m0, s49, 106496
    s_nop 0
    global_load_lds_dwordx4 v[34:35], off
    v_lshl_add_u64 v[34:35], s[38:39], 0, v[34:35]
    s_add_u32 s43, s43, 32768
    buffer_load_dwordx4 v[192:195], v1, s[4:7], s43 offen offset:0 sc0 sc1 nt
    buffer_load_dwordx4 v[196:199], v1, s[4:7], s43 offen offset:1024 sc0 sc1 nt
    buffer_load_dwordx4 v[200:203], v1, s[4:7], s43 offen offset:2048 sc0 sc1 nt
    buffer_load_dwordx4 v[204:207], v1, s[4:7], s43 offen offset:3072 sc0 sc1 nt
    v_add_f32_dpp v20, v20, v20 row_ror:8 row_mask:0xf bank_mask:0x3
    v_add_f32_dpp v22, v22, v22 row_ror:8 row_mask:0xf bank_mask:0x3
    s_nop 0
    v_add_f32_dpp v20, v21, v21 row_ror:8 row_mask:0xf bank_mask:0xc
    v_add_f32_dpp v22, v23, v23 row_ror:8 row_mask:0xf bank_mask:0xc
    s_nop 0
    v_add_f32_dpp v20, v20, v20 row_half_mirror row_mask:0xf bank_mask:0x5
    s_nop 1
    v_add_f32_dpp v20, v22, v22 row_half_mirror row_mask:0xf bank_mask:0xa
    s_nop 1
    v_add_f32_dpp v20, v20, v20 quad_perm:[1,0,3,2] row_mask:0xf bank_mask:0xf
    s_nop 1
    v_add_f32_dpp v20, v20, v20 quad_perm:[2,3,0,1] row_mask:0xf bank_mask:0xf
    v_cvt_pk_bf16_f32 v20, v20, v20
    v_and_b32 v20, s50, v20
    v_mul_f32 v20, s51, v20
    v_cvt_pk_bf16_f32 v20, v20, v20
    v_and_b32 v20, s50, v20
    s_nop 1
    v_max_f32_dpp v21, v20, v20 row_ror:4 row_mask:0xf bank_mask:0xf
    s_nop 1
    v_max_f32_dpp v21, v21, v21 row_ror:8 row_mask:0xf bank_mask:0xf
    v_max_f32 v21, v21, v5
    v_sub_f32 v22, v5, v21
    v_sub_f32 v20, v20, v21
    v_mov_b32 v5, v21
    v_mul_f32 v22, s52, v22
    v_mul_f32 v20, s52, v20
    v_exp_f32 v26, v22
    v_exp_f32 v20, v20
    v_pk_mul_f32 v[8:9], v[8:9], v[26:27] op_sel_hi:[1,0]
    v_pk_mul_f32 v[10:11], v[10:11], v[26:27] op_sel_hi:[1,0]
    v_pk_mul_f32 v[12:13], v[12:13], v[26:27] op_sel_hi:[1,0]
    v_pk_mul_f32 v[14:15], v[14:15], v[26:27] op_sel_hi:[1,0]
    v_cvt_pk_bf16_f32 v24, v20, 0
    v_cvt_pk_bf16_f32 v25, 0, v20
    v_fma_f32 v6, v6, v26, v20
    s_waitcnt vmcnt(35)
    v_dot2c_f32_bf16_dpp v8, v24, v208 row_newbcast:0 row_mask:0xf bank_mask:0xf
    v_dot2c_f32_bf16_dpp v9, v25, v208 row_newbcast:0 row_mask:0xf bank_mask:0xf
    v_dot2c_f32_bf16_dpp v10, v24, v209 row_newbcast:0 row_mask:0xf bank_mask:0xf
    v_dot2c_f32_bf16_dpp v11, v25, v209 row_newbcast:0 row_mask:0xf bank_mask:0xf
    v_dot2c_f32_bf16_dpp v12, v24, v210 row_newbcast:0 row_mask:0xf bank_mask:0xf
    v_dot2c_f32_bf16_dpp v13, v25, v210 row_newbcast:0 row_mask:0xf bank_mask:0xf
    v_dot2c_f32_bf16_dpp v14, v24, v211 row_newbcast:0 row_mask:0xf bank_mask:0xf
    v_dot2c_f32_bf16_dpp v15, v25, v211 row_newbcast:0 row_mask:0xf bank_mask:0xf
    v_dot2c_f32_bf16_dpp v8, v24, v212 row_newbcast:8 row_mask:0xf bank_mask:0xf
    v_dot2c_f32_bf16_dpp v9, v25, v212 row_newbcast:8 row_mask:0xf bank_mask:0xf
    v_dot2c_f32_bf16_dpp v10, v24, v213 row_newbcast:8 row_mask:0xf bank_mask:0xf
    v_dot2c_f32_bf16_dpp v11, v25, v213 row_newbcast:8 row_mask:0xf bank_mask:0xf
    v_dot2c_f32_bf16_dpp v12, v24, v214 row_newbcast:8 row_mask:0xf bank_mask:0xf
    v_dot2c_f32_bf16_dpp v13, v25, v214 row_newbcast:8 row_mask:0xf bank_mask:0xf
    v_dot2c_f32_bf16_dpp v14, v24, v215 row_newbcast:8 row_mask:0xf bank_mask:0xf
    v_dot2c_f32_bf16_dpp v15, v25, v215 row_newbcast:8 row_mask:0xf bank_mask:0xf
    v_dot2c_f32_bf16_dpp v8, v24, v216 row_newbcast:4 row_mask:0xf bank_mask:0xf
    v_dot2c_f32_bf16_dpp v9, v25, v216 row_newbcast:4 row_mask:0xf bank_mask:0xf
    v_dot2c_f32_bf16_dpp v10, v24, v217 row_newbcast:4 row_mask:0xf bank_mask:0xf
    v_dot2c_f32_bf16_dpp v11, v25, v217 row_newbcast:4 row_mask:0xf bank_mask:0xf
    v_dot2c_f32_bf16_dpp v12, v24, v218 row_newbcast:4 row_mask:0xf bank_mask:0xf
    v_dot2c_f32_bf16_dpp v13, v25, v218 row_newbcast:4 row_mask:0xf bank_mask:0xf
    v_dot2c_f32_bf16_dpp v14, v24, v219 row_newbcast:4 row_mask:0xf bank_mask:0xf
    v_dot2c_f32_bf16_dpp v15, v25, v219 row_newbcast:4 row_mask:0xf bank_mask:0xf
    v_dot2c_f32_bf16_dpp v8, v24, v220 row_newbcast:12 row_mask:0xf bank_mask:0xf
    v_dot2c_f32_bf16_dpp v9, v25, v220 row_newbcast:12 row_mask:0xf bank_mask:0xf
    v_dot2c_f32_bf16_dpp v10, v24, v221 row_newbcast:12 row_mask:0xf bank_mask:0xf
    v_dot2c_f32_bf16_dpp v11, v25, v221 row_newbcast:12 row_mask:0xf bank_mask:0xf
    v_dot2c_f32_bf16_dpp v12, v24, v222 row_newbcast:12 row_mask:0xf bank_mask:0xf
    v_dot2c_f32_bf16_dpp v13, v25, v222 row_newbcast:12 row_mask:0xf bank_mask:0xf
    v_dot2c_f32_bf16_dpp v14, v24, v223 row_newbcast:12 row_mask:0xf bank_mask:0xf
    v_dot2c_f32_bf16_dpp v15, v25, v223 row_newbcast:12 row_mask:0xf bank_mask:0xf
    s_add_u32 m0, s49, 114688
    s_nop 0
    global_load_lds_dwordx4 v[34:35], off
    v_lshl_add_u64 v[34:35], s[38:39], 0, v[34:35]
    buffer_load_dwordx4 v[208:211], v1, s[8:11], s43 offen offset:0 sc0 sc1 nt
    buffer_load_dwordx4 v[212:215], v1, s[8:11], s43 offen offset:1024 sc0 sc1 nt
    buffer_load_dwordx4 v[216:219], v1, s[8:11], s43 offen offset:2048 sc0 sc1 nt
    buffer_load_dwordx4 v[220:223], v1, s[8:11], s43 offen offset:3072 sc0 sc1 nt
    s_waitcnt vmcnt(35)
    v_dot2_f32_bf16 v20, v224, v16, 0
    v_dot2_f32_bf16 v21, v228, v16, 0
    v_dot2_f32_bf16 v22, v232, v16, 0
    v_dot2_f32_bf16 v23, v236, v16, 0
    v_dot2c_f32_bf16 v20, v225, v17
    v_dot2c_f32_bf16 v21, v229, v17
    v_dot2c_f32_bf16 v22, v233, v17
    v_dot2c_f32_bf16 v23, v237, v17
    v_dot2c_f32_bf16 v20, v226, v18
    v_dot2c_f32_bf16 v21, v230, v18
    v_dot2c_f32_bf16 v22, v234, v18
    v_dot2c_f32_bf16 v23, v238, v18
    v_dot2c_f32_bf16 v20, v227, v19
    v_dot2c_f32_bf16 v21, v231, v19
    v_dot2c_f32_bf16 v22, v235, v19
    v_dot2c_f32_bf16 v23, v239, v19
    s_add_u32 m0, s49, 122880
    s_nop 0
    global_load_lds_dwordx4 v[34:35], off
    v_lshl_add_u64 v[34:35], s[38:39], 0, v[34:35]
    s_add_u32 s43, s43, 32768
    buffer_load_dwordx4 v[224:227], v1, s[4:7], s43 offen offset:0 sc0 sc1 nt
    buffer_load_dwordx4 v[228:231], v1, s[4:7], s43 offen offset:1024 sc0 sc1 nt
    buffer_load_dwordx4 v[232:235], v1, s[4:7], s43 offen offset:2048 sc0 sc1 nt
    buffer_load_dwordx4 v[236:239], v1, s[4:7], s43 offen offset:3072 sc0 sc1 nt
    v_add_f32_dpp v20, v20, v20 row_ror:8 row_mask:0xf bank_mask:0x3
    v_add_f32_dpp v22, v22, v22 row_ror:8 row_mask:0xf bank_mask:0x3
    s_nop 0
    v_add_f32_dpp v20, v21, v21 row_ror:8 row_mask:0xf bank_mask:0xc
    v_add_f32_dpp v22, v23, v23 row_ror:8 row_mask:0xf bank_mask:0xc
    s_nop 0
    v_add_f32_dpp v20, v20, v20 row_half_mirror row_mask:0xf bank_mask:0x5
    s_nop 1
    v_add_f32_dpp v20, v22, v22 row_half_mirror row_mask:0xf bank_mask:0xa
    s_nop 1
    v_add_f32_dpp v20, v20, v20 quad_perm:[1,0,3,2] row_mask:0xf bank_mask:0xf
    s_nop 1
    v_add_f32_dpp v20, v20, v20 quad_perm:[2,3,0,1] row_mask:0xf bank_mask:0xf
    v_cvt_pk_bf16_f32 v20, v20, v20
    v_and_b32 v20, s50, v20
    v_mul_f32 v20, s51, v20
    v_cvt_pk_bf16_f32 v20, v20, v20
    v_and_b32 v20, s50, v20
    s_nop 1
    v_max_f32_dpp v21, v20, v20 row_ror:4 row_mask:0xf bank_mask:0xf
    s_nop 1
    v_max_f32_dpp v21, v21, v21 row_ror:8 row_mask:0xf bank_mask:0xf
    v_max_f32 v21, v21, v5
    v_sub_f32 v22, v5, v21
    v_sub_f32 v20, v20, v21
    v_mov_b32 v5, v21
    v_mul_f32 v22, s52, v22
    v_mul_f32 v20, s52, v20
    v_exp_f32 v26, v22
    v_exp_f32 v20, v20
    v_pk_mul_f32 v[8:9], v[8:9], v[26:27] op_sel_hi:[1,0]
    v_pk_mul_f32 v[10:11], v[10:11], v[26:27] op_sel_hi:[1,0]
    v_pk_mul_f32 v[12:13], v[12:13], v[26:27] op_sel_hi:[1,0]
    v_pk_mul_f32 v[14:15], v[14:15], v[26:27] op_sel_hi:[1,0]
    v_cvt_pk_bf16_f32 v24, v20, 0
    v_cvt_pk_bf16_f32 v25, 0, v20
    v_fma_f32 v6, v6, v26, v20
    s_waitcnt vmcnt(35)
    v_dot2c_f32_bf16_dpp v8, v24, v240 row_newbcast:0 row_mask:0xf bank_mask:0xf
    v_dot2c_f32_bf16_dpp v9, v25, v240 row_newbcast:0 row_mask:0xf bank_mask:0xf
    v_dot2c_f32_bf16_dpp v10, v24, v241 row_newbcast:0 row_mask:0xf bank_mask:0xf
    v_dot2c_f32_bf16_dpp v11, v25, v241 row_newbcast:0 row_mask:0xf bank_mask:0xf
    v_dot2c_f32_bf16_dpp v12, v24, v242 row_newbcast:0 row_mask:0xf bank_mask:0xf
    v_dot2c_f32_bf16_dpp v13, v25, v242 row_newbcast:0 row_mask:0xf bank_mask:0xf
    v_dot2c_f32_bf16_dpp v14, v24, v243 row_newbcast:0 row_mask:0xf bank_mask:0xf
    v_dot2c_f32_bf16_dpp v15, v25, v243 row_newbcast:0 row_mask:0xf bank_mask:0xf
    v_dot2c_f32_bf16_dpp v8, v24, v244 row_newbcast:8 row_mask:0xf bank_mask:0xf
    v_dot2c_f32_bf16_dpp v9, v25, v244 row_newbcast:8 row_mask:0xf bank_mask:0xf
    v_dot2c_f32_bf16_dpp v10, v24, v245 row_newbcast:8 row_mask:0xf bank_mask:0xf
    v_dot2c_f32_bf16_dpp v11, v25, v245 row_newbcast:8 row_mask:0xf bank_mask:0xf
    v_dot2c_f32_bf16_dpp v12, v24, v246 row_newbcast:8 row_mask:0xf bank_mask:0xf
    v_dot2c_f32_bf16_dpp v13, v25, v246 row_newbcast:8 row_mask:0xf bank_mask:0xf
    v_dot2c_f32_bf16_dpp v14, v24, v247 row_newbcast:8 row_mask:0xf bank_mask:0xf
    v_dot2c_f32_bf16_dpp v15, v25, v247 row_newbcast:8 row_mask:0xf bank_mask:0xf
    v_dot2c_f32_bf16_dpp v8, v24, v248 row_newbcast:4 row_mask:0xf bank_mask:0xf
    v_dot2c_f32_bf16_dpp v9, v25, v248 row_newbcast:4 row_mask:0xf bank_mask:0xf
    v_dot2c_f32_bf16_dpp v10, v24, v249 row_newbcast:4 row_mask:0xf bank_mask:0xf
    v_dot2c_f32_bf16_dpp v11, v25, v249 row_newbcast:4 row_mask:0xf bank_mask:0xf
    v_dot2c_f32_bf16_dpp v12, v24, v250 row_newbcast:4 row_mask:0xf bank_mask:0xf
    v_dot2c_f32_bf16_dpp v13, v25, v250 row_newbcast:4 row_mask:0xf bank_mask:0xf
    v_dot2c_f32_bf16_dpp v14, v24, v251 row_newbcast:4 row_mask:0xf bank_mask:0xf
    v_dot2c_f32_bf16_dpp v15, v25, v251 row_newbcast:4 row_mask:0xf bank_mask:0xf
    v_dot2c_f32_bf16_dpp v8, v24, v252 row_newbcast:12 row_mask:0xf bank_mask:0xf
    v_dot2c_f32_bf16_dpp v9, v25, v252 row_newbcast:12 row_mask:0xf bank_mask:0xf
    v_dot2c_f32_bf16_dpp v10, v24, v253 row_newbcast:12 row_mask:0xf bank_mask:0xf
    v_dot2c_f32_bf16_dpp v11, v25, v253 row_newbcast:12 row_mask:0xf bank_mask:0xf
    v_dot2c_f32_bf16_dpp v12, v24, v254 row_newbcast:12 row_mask:0xf bank_mask:0xf
    v_dot2c_f32_bf16_dpp v13, v25, v254 row_newbcast:12 row_mask:0xf bank_mask:0xf
    v_dot2c_f32_bf16_dpp v14, v24, v255 row_newbcast:12 row_mask:0xf bank_mask:0xf
    v_dot2c_f32_bf16_dpp v15, v25, v255 row_newbcast:12 row_mask:0xf bank_mask:0xf
    buffer_load_dwordx4 v[240:243], v1, s[8:11], s43 offen offset:0 sc0 sc1 nt
    buffer_load_dwordx4 v[244:247], v1, s[8:11], s43 offen offset:1024 sc0 sc1 nt
    buffer_load_dwordx4 v[248:251], v1, s[8:11], s43 offen offset:2048 sc0 sc1 nt
    buffer_load_dwordx4 v[252:255], v1, s[8:11], s43 offen offset:3072 sc0 sc1 nt
    s_waitcnt vmcnt(34)
    v_dot2_f32_bf16 v20, v40, v16, 0
    v_dot2_f32_bf16 v21, v44, v16, 0
    v_dot2_f32_bf16 v22, v48, v16, 0
    v_dot2_f32_bf16 v23, v52, v16, 0
    v_dot2c_f32_bf16 v20, v41, v17
    v_dot2c_f32_bf16 v21, v45, v17
    v_dot2c_f32_bf16 v22, v49, v17
    v_dot2c_f32_bf16 v23, v53, v17
    v_dot2c_f32_bf16 v20, v42, v18
    v_dot2c_f32_bf16 v21, v46, v18
    v_dot2c_f32_bf16 v22, v50, v18
    v_dot2c_f32_bf16 v23, v54, v18
    v_dot2c_f32_bf16 v20, v43, v19
    v_dot2c_f32_bf16 v21, v47, v19
    v_dot2c_f32_bf16 v22, v51, v19
    v_dot2c_f32_bf16 v23, v55, v19
    s_add_u32 s43, s43, 32768
    buffer_load_dwordx4 v[40:43], v1, s[4:7], s43 offen offset:0 sc0 sc1 nt
    buffer_load_dwordx4 v[44:47], v1, s[4:7], s43 offen offset:1024 sc0 sc1 nt
    buffer_load_dwordx4 v[48:51], v1, s[4:7], s43 offen offset:2048 sc0 sc1 nt
    buffer_load_dwordx4 v[52:55], v1, s[4:7], s43 offen offset:3072 sc0 sc1 nt
    v_add_f32_dpp v20, v20, v20 row_ror:8 row_mask:0xf bank_mask:0x3
    v_add_f32_dpp v22, v22, v22 row_ror:8 row_mask:0xf bank_mask:0x3
    s_nop 0
    v_add_f32_dpp v20, v21, v21 row_ror:8 row_mask:0xf bank_mask:0xc
    v_add_f32_dpp v22, v23, v23 row_ror:8 row_mask:0xf bank_mask:0xc
    s_nop 0
    v_add_f32_dpp v20, v20, v20 row_half_mirror row_mask:0xf bank_mask:0x5
    s_nop 1
    v_add_f32_dpp v20, v22, v22 row_half_mirror row_mask:0xf bank_mask:0xa
    s_nop 1
    v_add_f32_dpp v20, v20, v20 quad_perm:[1,0,3,2] row_mask:0xf bank_mask:0xf
    s_nop 1
    v_add_f32_dpp v20, v20, v20 quad_perm:[2,3,0,1] row_mask:0xf bank_mask:0xf
    v_cvt_pk_bf16_f32 v20, v20, v20
    v_and_b32 v20, s50, v20
    v_mul_f32 v20, s51, v20
    v_cvt_pk_bf16_f32 v20, v20, v20
    v_and_b32 v20, s50, v20
    s_nop 1
    v_max_f32_dpp v21, v20, v20 row_ror:4 row_mask:0xf bank_mask:0xf
    s_nop 1
    v_max_f32_dpp v21, v21, v21 row_ror:8 row_mask:0xf bank_mask:0xf
    v_max_f32 v21, v21, v5
    v_sub_f32 v22, v5, v21
    v_sub_f32 v20, v20, v21
    v_mov_b32 v5, v21
    v_mul_f32 v22, s52, v22
    v_mul_f32 v20, s52, v20
    v_exp_f32 v26, v22
    v_exp_f32 v20, v20
    v_pk_mul_f32 v[8:9], v[8:9], v[26:27] op_sel_hi:[1,0]
    v_pk_mul_f32 v[10:11], v[10:11], v[26:27] op_sel_hi:[1,0]
    v_pk_mul_f32 v[12:13], v[12:13], v[26:27] op_sel_hi:[1,0]
    v_pk_mul_f32 v[14:15], v[14:15], v[26:27] op_sel_hi:[1,0]
    v_cvt_pk_bf16_f32 v24, v20, 0
    v_cvt_pk_bf16_f32 v25, 0, v20
    v_fma_f32 v6, v6, v26, v20
    s_waitcnt vmcnt(33)
    v_dot2c_f32_bf16_dpp v8, v24, v56 row_newbcast:0 row_mask:0xf bank_mask:0xf
    v_dot2c_f32_bf16_dpp v9, v25, v56 row_newbcast:0 row_mask:0xf bank_mask:0xf
    v_dot2c_f32_bf16_dpp v10, v24, v57 row_newbcast:0 row_mask:0xf bank_mask:0xf
    v_dot2c_f32_bf16_dpp v11, v25, v57 row_newbcast:0 row_mask:0xf bank_mask:0xf
    v_dot2c_f32_bf16_dpp v12, v24, v58 row_newbcast:0 row_mask:0xf bank_mask:0xf
    v_dot2c_f32_bf16_dpp v13, v25, v58 row_newbcast:0 row_mask:0xf bank_mask:0xf
    v_dot2c_f32_bf16_dpp v14, v24, v59 row_newbcast:0 row_mask:0xf bank_mask:0xf
    v_dot2c_f32_bf16_dpp v15, v25, v59 row_newbcast:0 row_mask:0xf bank_mask:0xf
    v_dot2c_f32_bf16_dpp v8, v24, v60 row_newbcast:8 row_mask:0xf bank_mask:0xf
    v_dot2c_f32_bf16_dpp v9, v25, v60 row_newbcast:8 row_mask:0xf bank_mask:0xf
    v_dot2c_f32_bf16_dpp v10, v24, v61 row_newbcast:8 row_mask:0xf bank_mask:0xf
    v_dot2c_f32_bf16_dpp v11, v25, v61 row_newbcast:8 row_mask:0xf bank_mask:0xf
    v_dot2c_f32_bf16_dpp v12, v24, v62 row_newbcast:8 row_mask:0xf bank_mask:0xf
    v_dot2c_f32_bf16_dpp v13, v25, v62 row_newbcast:8 row_mask:0xf bank_mask:0xf
    v_dot2c_f32_bf16_dpp v14, v24, v63 row_newbcast:8 row_mask:0xf bank_mask:0xf
    v_dot2c_f32_bf16_dpp v15, v25, v63 row_newbcast:8 row_mask:0xf bank_mask:0xf
    v_dot2c_f32_bf16_dpp v8, v24, v64 row_newbcast:4 row_mask:0xf bank_mask:0xf
    v_dot2c_f32_bf16_dpp v9, v25, v64 row_newbcast:4 row_mask:0xf bank_mask:0xf
    v_dot2c_f32_bf16_dpp v10, v24, v65 row_newbcast:4 row_mask:0xf bank_mask:0xf
    v_dot2c_f32_bf16_dpp v11, v25, v65 row_newbcast:4 row_mask:0xf bank_mask:0xf
    v_dot2c_f32_bf16_dpp v12, v24, v66 row_newbcast:4 row_mask:0xf bank_mask:0xf
    v_dot2c_f32_bf16_dpp v13, v25, v66 row_newbcast:4 row_mask:0xf bank_mask:0xf
    v_dot2c_f32_bf16_dpp v14, v24, v67 row_newbcast:4 row_mask:0xf bank_mask:0xf
    v_dot2c_f32_bf16_dpp v15, v25, v67 row_newbcast:4 row_mask:0xf bank_mask:0xf
    v_dot2c_f32_bf16_dpp v8, v24, v68 row_newbcast:12 row_mask:0xf bank_mask:0xf
    v_dot2c_f32_bf16_dpp v9, v25, v68 row_newbcast:12 row_mask:0xf bank_mask:0xf
    v_dot2c_f32_bf16_dpp v10, v24, v69 row_newbcast:12 row_mask:0xf bank_mask:0xf
    v_dot2c_f32_bf16_dpp v11, v25, v69 row_newbcast:12 row_mask:0xf bank_mask:0xf
    v_dot2c_f32_bf16_dpp v12, v24, v70 row_newbcast:12 row_mask:0xf bank_mask:0xf
    v_dot2c_f32_bf16_dpp v13, v25, v70 row_newbcast:12 row_mask:0xf bank_mask:0xf
    v_dot2c_f32_bf16_dpp v14, v24, v71 row_newbcast:12 row_mask:0xf bank_mask:0xf
    v_dot2c_f32_bf16_dpp v15, v25, v71 row_newbcast:12 row_mask:0xf bank_mask:0xf
    buffer_load_dwordx4 v[56:59], v1, s[8:11], s43 offen offset:0 sc0 sc1 nt
    buffer_load_dwordx4 v[60:63], v1, s[8:11], s43 offen offset:1024 sc0 sc1 nt
    buffer_load_dwordx4 v[64:67], v1, s[8:11], s43 offen offset:2048 sc0 sc1 nt
    buffer_load_dwordx4 v[68:71], v1, s[8:11], s43 offen offset:3072 sc0 sc1 nt
    s_waitcnt vmcnt(32)
    v_dot2_f32_bf16 v20, v72, v16, 0
    v_dot2_f32_bf16 v21, v76, v16, 0
    v_dot2_f32_bf16 v22, v80, v16, 0
    v_dot2_f32_bf16 v23, v84, v16, 0
    v_dot2c_f32_bf16 v20, v73, v17
    v_dot2c_f32_bf16 v21, v77, v17
    v_dot2c_f32_bf16 v22, v81, v17
    v_dot2c_f32_bf16 v23, v85, v17
    v_dot2c_f32_bf16 v20, v74, v18
    v_dot2c_f32_bf16 v21, v78, v18
    v_dot2c_f32_bf16 v22, v82, v18
    v_dot2c_f32_bf16 v23, v86, v18
    v_dot2c_f32_bf16 v20, v75, v19
    v_dot2c_f32_bf16 v21, v79, v19
    v_dot2c_f32_bf16 v22, v83, v19
    v_dot2c_f32_bf16 v23, v87, v19
    s_add_u32 s43, s43, 32768
    buffer_load_dwordx4 v[72:75], v1, s[4:7], s43 offen offset:0 sc0 sc1 nt
    buffer_load_dwordx4 v[76:79], v1, s[4:7], s43 offen offset:1024 sc0 sc1 nt
    buffer_load_dwordx4 v[80:83], v1, s[4:7], s43 offen offset:2048 sc0 sc1 nt
    buffer_load_dwordx4 v[84:87], v1, s[4:7], s43 offen offset:3072 sc0 sc1 nt
    v_add_f32_dpp v20, v20, v20 row_ror:8 row_mask:0xf bank_mask:0x3
    v_add_f32_dpp v22, v22, v22 row_ror:8 row_mask:0xf bank_mask:0x3
    s_nop 0
    v_add_f32_dpp v20, v21, v21 row_ror:8 row_mask:0xf bank_mask:0xc
    v_add_f32_dpp v22, v23, v23 row_ror:8 row_mask:0xf bank_mask:0xc
    s_nop 0
    v_add_f32_dpp v20, v20, v20 row_half_mirror row_mask:0xf bank_mask:0x5
    s_nop 1
    v_add_f32_dpp v20, v22, v22 row_half_mirror row_mask:0xf bank_mask:0xa
    s_nop 1
    v_add_f32_dpp v20, v20, v20 quad_perm:[1,0,3,2] row_mask:0xf bank_mask:0xf
    s_nop 1
    v_add_f32_dpp v20, v20, v20 quad_perm:[2,3,0,1] row_mask:0xf bank_mask:0xf
    v_cvt_pk_bf16_f32 v20, v20, v20
    v_and_b32 v20, s50, v20
    v_mul_f32 v20, s51, v20
    v_cvt_pk_bf16_f32 v20, v20, v20
    v_and_b32 v20, s50, v20
    s_nop 1
    v_max_f32_dpp v21, v20, v20 row_ror:4 row_mask:0xf bank_mask:0xf
    s_nop 1
    v_max_f32_dpp v21, v21, v21 row_ror:8 row_mask:0xf bank_mask:0xf
    v_max_f32 v21, v21, v5
    v_sub_f32 v22, v5, v21
    v_sub_f32 v20, v20, v21
    v_mov_b32 v5, v21
    v_mul_f32 v22, s52, v22
    v_mul_f32 v20, s52, v20
    v_exp_f32 v26, v22
    v_exp_f32 v20, v20
    v_pk_mul_f32 v[8:9], v[8:9], v[26:27] op_sel_hi:[1,0]
    v_pk_mul_f32 v[10:11], v[10:11], v[26:27] op_sel_hi:[1,0]
    v_pk_mul_f32 v[12:13], v[12:13], v[26:27] op_sel_hi:[1,0]
    v_pk_mul_f32 v[14:15], v[14:15], v[26:27] op_sel_hi:[1,0]
    v_cvt_pk_bf16_f32 v24, v20, 0
    v_cvt_pk_bf16_f32 v25, 0, v20
    v_fma_f32 v6, v6, v26, v20
    s_waitcnt vmcnt(31)
    v_dot2c_f32_bf16_dpp v8, v24, v88 row_newbcast:0 row_mask:0xf bank_mask:0xf
    v_dot2c_f32_bf16_dpp v9, v25, v88 row_newbcast:0 row_mask:0xf bank_mask:0xf
    v_dot2c_f32_bf16_dpp v10, v24, v89 row_newbcast:0 row_mask:0xf bank_mask:0xf
    v_dot2c_f32_bf16_dpp v11, v25, v89 row_newbcast:0 row_mask:0xf bank_mask:0xf
    v_dot2c_f32_bf16_dpp v12, v24, v90 row_newbcast:0 row_mask:0xf bank_mask:0xf
    v_dot2c_f32_bf16_dpp v13, v25, v90 row_newbcast:0 row_mask:0xf bank_mask:0xf
    v_dot2c_f32_bf16_dpp v14, v24, v91 row_newbcast:0 row_mask:0xf bank_mask:0xf
    v_dot2c_f32_bf16_dpp v15, v25, v91 row_newbcast:0 row_mask:0xf bank_mask:0xf
    v_dot2c_f32_bf16_dpp v8, v24, v92 row_newbcast:8 row_mask:0xf bank_mask:0xf
    v_dot2c_f32_bf16_dpp v9, v25, v92 row_newbcast:8 row_mask:0xf bank_mask:0xf
    v_dot2c_f32_bf16_dpp v10, v24, v93 row_newbcast:8 row_mask:0xf bank_mask:0xf
    v_dot2c_f32_bf16_dpp v11, v25, v93 row_newbcast:8 row_mask:0xf bank_mask:0xf
    v_dot2c_f32_bf16_dpp v12, v24, v94 row_newbcast:8 row_mask:0xf bank_mask:0xf
    v_dot2c_f32_bf16_dpp v13, v25, v94 row_newbcast:8 row_mask:0xf bank_mask:0xf
    v_dot2c_f32_bf16_dpp v14, v24, v95 row_newbcast:8 row_mask:0xf bank_mask:0xf
    v_dot2c_f32_bf16_dpp v15, v25, v95 row_newbcast:8 row_mask:0xf bank_mask:0xf
    v_dot2c_f32_bf16_dpp v8, v24, v96 row_newbcast:4 row_mask:0xf bank_mask:0xf
    v_dot2c_f32_bf16_dpp v9, v25, v96 row_newbcast:4 row_mask:0xf bank_mask:0xf
    v_dot2c_f32_bf16_dpp v10, v24, v97 row_newbcast:4 row_mask:0xf bank_mask:0xf
    v_dot2c_f32_bf16_dpp v11, v25, v97 row_newbcast:4 row_mask:0xf bank_mask:0xf
    v_dot2c_f32_bf16_dpp v12, v24, v98 row_newbcast:4 row_mask:0xf bank_mask:0xf
    v_dot2c_f32_bf16_dpp v13, v25, v98 row_newbcast:4 row_mask:0xf bank_mask:0xf
    v_dot2c_f32_bf16_dpp v14, v24, v99 row_newbcast:4 row_mask:0xf bank_mask:0xf
    v_dot2c_f32_bf16_dpp v15, v25, v99 row_newbcast:4 row_mask:0xf bank_mask:0xf
    v_dot2c_f32_bf16_dpp v8, v24, v100 row_newbcast:12 row_mask:0xf bank_mask:0xf
    v_dot2c_f32_bf16_dpp v9, v25, v100 row_newbcast:12 row_mask:0xf bank_mask:0xf
    v_dot2c_f32_bf16_dpp v10, v24, v101 row_newbcast:12 row_mask:0xf bank_mask:0xf
    v_dot2c_f32_bf16_dpp v11, v25, v101 row_newbcast:12 row_mask:0xf bank_mask:0xf
    v_dot2c_f32_bf16_dpp v12, v24, v102 row_newbcast:12 row_mask:0xf bank_mask:0xf
    v_dot2c_f32_bf16_dpp v13, v25, v102 row_newbcast:12 row_mask:0xf bank_mask:0xf
    v_dot2c_f32_bf16_dpp v14, v24, v103 row_newbcast:12 row_mask:0xf bank_mask:0xf
    v_dot2c_f32_bf16_dpp v15, v25, v103 row_newbcast:12 row_mask:0xf bank_mask:0xf
    buffer_load_dwordx4 v[88:91], v1, s[8:11], s43 offen offset:0 sc0 sc1 nt
    buffer_load_dwordx4 v[92:95], v1, s[8:11], s43 offen offset:1024 sc0 sc1 nt
    buffer_load_dwordx4 v[96:99], v1, s[8:11], s43 offen offset:2048 sc0 sc1 nt
    buffer_load_dwordx4 v[100:103], v1, s[8:11], s43 offen offset:3072 sc0 sc1 nt
    s_waitcnt vmcnt(30)
    v_dot2_f32_bf16 v20, v192, v16, 0
    v_dot2_f32_bf16 v21, v196, v16, 0
    v_dot2_f32_bf16 v22, v200, v16, 0
    v_dot2_f32_bf16 v23, v204, v16, 0
    v_dot2c_f32_bf16 v20, v193, v17
    v_dot2c_f32_bf16 v21, v197, v17
    v_dot2c_f32_bf16 v22, v201, v17
    v_dot2c_f32_bf16 v23, v205, v17
    v_dot2c_f32_bf16 v20, v194, v18
    v_dot2c_f32_bf16 v21, v198, v18
    v_dot2c_f32_bf16 v22, v202, v18
    v_dot2c_f32_bf16 v23, v206, v18
    v_dot2c_f32_bf16 v20, v195, v19
    v_dot2c_f32_bf16 v21, v199, v19
    v_dot2c_f32_bf16 v22, v203, v19
    v_dot2c_f32_bf16 v23, v207, v19
    s_add_u32 s43, s43, 32768
    buffer_load_dwordx4 v[192:195], v1, s[4:7], s43 offen offset:0 sc0 sc1 nt
    buffer_load_dwordx4 v[196:199], v1, s[4:7], s43 offen offset:1024 sc0 sc1 nt
    buffer_load_dwordx4 v[200:203], v1, s[4:7], s43 offen offset:2048 sc0 sc1 nt
    buffer_load_dwordx4 v[204:207], v1, s[4:7], s43 offen offset:3072 sc0 sc1 nt
    v_add_f32_dpp v20, v20, v20 row_ror:8 row_mask:0xf bank_mask:0x3
    v_add_f32_dpp v22, v22, v22 row_ror:8 row_mask:0xf bank_mask:0x3
    s_nop 0
    v_add_f32_dpp v20, v21, v21 row_ror:8 row_mask:0xf bank_mask:0xc
    v_add_f32_dpp v22, v23, v23 row_ror:8 row_mask:0xf bank_mask:0xc
    s_nop 0
    v_add_f32_dpp v20, v20, v20 row_half_mirror row_mask:0xf bank_mask:0x5
    s_nop 1
    v_add_f32_dpp v20, v22, v22 row_half_mirror row_mask:0xf bank_mask:0xa
    s_nop 1
    v_add_f32_dpp v20, v20, v20 quad_perm:[1,0,3,2] row_mask:0xf bank_mask:0xf
    s_nop 1
    v_add_f32_dpp v20, v20, v20 quad_perm:[2,3,0,1] row_mask:0xf bank_mask:0xf
    v_cvt_pk_bf16_f32 v20, v20, v20
    v_and_b32 v20, s50, v20
    v_mul_f32 v20, s51, v20
    v_cvt_pk_bf16_f32 v20, v20, v20
    v_and_b32 v20, s50, v20
    s_nop 1
    v_max_f32_dpp v21, v20, v20 row_ror:4 row_mask:0xf bank_mask:0xf
    s_nop 1
    v_max_f32_dpp v21, v21, v21 row_ror:8 row_mask:0xf bank_mask:0xf
    v_max_f32 v21, v21, v5
    v_sub_f32 v22, v5, v21
    v_sub_f32 v20, v20, v21
    v_mov_b32 v5, v21
    v_mul_f32 v22, s52, v22
    v_mul_f32 v20, s52, v20
    v_exp_f32 v26, v22
    v_exp_f32 v20, v20
    v_pk_mul_f32 v[8:9], v[8:9], v[26:27] op_sel_hi:[1,0]
    v_pk_mul_f32 v[10:11], v[10:11], v[26:27] op_sel_hi:[1,0]
    v_pk_mul_f32 v[12:13], v[12:13], v[26:27] op_sel_hi:[1,0]
    v_pk_mul_f32 v[14:15], v[14:15], v[26:27] op_sel_hi:[1,0]
    v_cvt_pk_bf16_f32 v24, v20, 0
    v_cvt_pk_bf16_f32 v25, 0, v20
    v_fma_f32 v6, v6, v26, v20
    s_waitcnt vmcnt(29)
    v_dot2c_f32_bf16_dpp v8, v24, v208 row_newbcast:0 row_mask:0xf bank_mask:0xf
    v_dot2c_f32_bf16_dpp v9, v25, v208 row_newbcast:0 row_mask:0xf bank_mask:0xf
    v_dot2c_f32_bf16_dpp v10, v24, v209 row_newbcast:0 row_mask:0xf bank_mask:0xf
    v_dot2c_f32_bf16_dpp v11, v25, v209 row_newbcast:0 row_mask:0xf bank_mask:0xf
    v_dot2c_f32_bf16_dpp v12, v24, v210 row_newbcast:0 row_mask:0xf bank_mask:0xf
    v_dot2c_f32_bf16_dpp v13, v25, v210 row_newbcast:0 row_mask:0xf bank_mask:0xf
    v_dot2c_f32_bf16_dpp v14, v24, v211 row_newbcast:0 row_mask:0xf bank_mask:0xf
    v_dot2c_f32_bf16_dpp v15, v25, v211 row_newbcast:0 row_mask:0xf bank_mask:0xf
    v_dot2c_f32_bf16_dpp v8, v24, v212 row_newbcast:8 row_mask:0xf bank_mask:0xf
    v_dot2c_f32_bf16_dpp v9, v25, v212 row_newbcast:8 row_mask:0xf bank_mask:0xf
    v_dot2c_f32_bf16_dpp v10, v24, v213 row_newbcast:8 row_mask:0xf bank_mask:0xf
    v_dot2c_f32_bf16_dpp v11, v25, v213 row_newbcast:8 row_mask:0xf bank_mask:0xf
    v_dot2c_f32_bf16_dpp v12, v24, v214 row_newbcast:8 row_mask:0xf bank_mask:0xf
    v_dot2c_f32_bf16_dpp v13, v25, v214 row_newbcast:8 row_mask:0xf bank_mask:0xf
    v_dot2c_f32_bf16_dpp v14, v24, v215 row_newbcast:8 row_mask:0xf bank_mask:0xf
    v_dot2c_f32_bf16_dpp v15, v25, v215 row_newbcast:8 row_mask:0xf bank_mask:0xf
    v_dot2c_f32_bf16_dpp v8, v24, v216 row_newbcast:4 row_mask:0xf bank_mask:0xf
    v_dot2c_f32_bf16_dpp v9, v25, v216 row_newbcast:4 row_mask:0xf bank_mask:0xf
    v_dot2c_f32_bf16_dpp v10, v24, v217 row_newbcast:4 row_mask:0xf bank_mask:0xf
    v_dot2c_f32_bf16_dpp v11, v25, v217 row_newbcast:4 row_mask:0xf bank_mask:0xf
    v_dot2c_f32_bf16_dpp v12, v24, v218 row_newbcast:4 row_mask:0xf bank_mask:0xf
    v_dot2c_f32_bf16_dpp v13, v25, v218 row_newbcast:4 row_mask:0xf bank_mask:0xf
    v_dot2c_f32_bf16_dpp v14, v24, v219 row_newbcast:4 row_mask:0xf bank_mask:0xf
    v_dot2c_f32_bf16_dpp v15, v25, v219 row_newbcast:4 row_mask:0xf bank_mask:0xf
    v_dot2c_f32_bf16_dpp v8, v24, v220 row_newbcast:12 row_mask:0xf bank_mask:0xf
    v_dot2c_f32_bf16_dpp v9, v25, v220 row_newbcast:12 row_mask:0xf bank_mask:0xf
    v_dot2c_f32_bf16_dpp v10, v24, v221 row_newbcast:12 row_mask:0xf bank_mask:0xf
    v_dot2c_f32_bf16_dpp v11, v25, v221 row_newbcast:12 row_mask:0xf bank_mask:0xf
    v_dot2c_f32_bf16_dpp v12, v24, v222 row_newbcast:12 row_mask:0xf bank_mask:0xf
    v_dot2c_f32_bf16_dpp v13, v25, v222 row_newbcast:12 row_mask:0xf bank_mask:0xf
    v_dot2c_f32_bf16_dpp v14, v24, v223 row_newbcast:12 row_mask:0xf bank_mask:0xf
    v_dot2c_f32_bf16_dpp v15, v25, v223 row_newbcast:12 row_mask:0xf bank_mask:0xf
    buffer_load_dwordx4 v[208:211], v1, s[8:11], s43 offen offset:0 sc0 sc1 nt
    buffer_load_dwordx4 v[212:215], v1, s[8:11], s43 offen offset:1024 sc0 sc1 nt
    buffer_load_dwordx4 v[216:219], v1, s[8:11], s43 offen offset:2048 sc0 sc1 nt
    buffer_load_dwordx4 v[220:223], v1, s[8:11], s43 offen offset:3072 sc0 sc1 nt
    s_waitcnt vmcnt(28)
    v_dot2_f32_bf16 v20, v224, v16, 0
    v_dot2_f32_bf16 v21, v228, v16, 0
    v_dot2_f32_bf16 v22, v232, v16, 0
    v_dot2_f32_bf16 v23, v236, v16, 0
    v_dot2c_f32_bf16 v20, v225, v17
    v_dot2c_f32_bf16 v21, v229, v17
    v_dot2c_f32_bf16 v22, v233, v17
    v_dot2c_f32_bf16 v23, v237, v17
    v_dot2c_f32_bf16 v20, v226, v18
    v_dot2c_f32_bf16 v21, v230, v18
    v_dot2c_f32_bf16 v22, v234, v18
    v_dot2c_f32_bf16 v23, v238, v18
    v_dot2c_f32_bf16 v20, v227, v19
    v_dot2c_f32_bf16 v21, v231, v19
    v_dot2c_f32_bf16 v22, v235, v19
    v_dot2c_f32_bf16 v23, v239, v19
    s_add_u32 s43, s43, 32768
    buffer_load_dwordx4 v[224:227], v1, s[4:7], s43 offen offset:0 sc0 sc1 nt
    buffer_load_dwordx4 v[228:231], v1, s[4:7], s43 offen offset:1024 sc0 sc1 nt
    buffer_load_dwordx4 v[232:235], v1, s[4:7], s43 offen offset:2048 sc0 sc1 nt
    buffer_load_dwordx4 v[236:239], v1, s[4:7], s43 offen offset:3072 sc0 sc1 nt
    v_add_f32_dpp v20, v20, v20 row_ror:8 row_mask:0xf bank_mask:0x3
    v_add_f32_dpp v22, v22, v22 row_ror:8 row_mask:0xf bank_mask:0x3
    s_nop 0
    v_add_f32_dpp v20, v21, v21 row_ror:8 row_mask:0xf bank_mask:0xc
    v_add_f32_dpp v22, v23, v23 row_ror:8 row_mask:0xf bank_mask:0xc
    s_nop 0
    v_add_f32_dpp v20, v20, v20 row_half_mirror row_mask:0xf bank_mask:0x5
    s_nop 1
    v_add_f32_dpp v20, v22, v22 row_half_mirror row_mask:0xf bank_mask:0xa
    s_nop 1
    v_add_f32_dpp v20, v20, v20 quad_perm:[1,0,3,2] row_mask:0xf bank_mask:0xf
    s_nop 1
    v_add_f32_dpp v20, v20, v20 quad_perm:[2,3,0,1] row_mask:0xf bank_mask:0xf
    v_cvt_pk_bf16_f32 v20, v20, v20
    v_and_b32 v20, s50, v20
    v_mul_f32 v20, s51, v20
    v_cvt_pk_bf16_f32 v20, v20, v20
    v_and_b32 v20, s50, v20
    s_nop 1
    v_max_f32_dpp v21, v20, v20 row_ror:4 row_mask:0xf bank_mask:0xf
    s_nop 1
    v_max_f32_dpp v21, v21, v21 row_ror:8 row_mask:0xf bank_mask:0xf
    v_max_f32 v21, v21, v5
    v_sub_f32 v22, v5, v21
    v_sub_f32 v20, v20, v21
    v_mov_b32 v5, v21
    v_mul_f32 v22, s52, v22
    v_mul_f32 v20, s52, v20
    v_exp_f32 v26, v22
    v_exp_f32 v20, v20
    v_pk_mul_f32 v[8:9], v[8:9], v[26:27] op_sel_hi:[1,0]
    v_pk_mul_f32 v[10:11], v[10:11], v[26:27] op_sel_hi:[1,0]
    v_pk_mul_f32 v[12:13], v[12:13], v[26:27] op_sel_hi:[1,0]
    v_pk_mul_f32 v[14:15], v[14:15], v[26:27] op_sel_hi:[1,0]
    v_cvt_pk_bf16_f32 v24, v20, 0
    v_cvt_pk_bf16_f32 v25, 0, v20
    v_fma_f32 v6, v6, v26, v20
    s_waitcnt vmcnt(28)
    v_dot2c_f32_bf16_dpp v8, v24, v240 row_newbcast:0 row_mask:0xf bank_mask:0xf
    v_dot2c_f32_bf16_dpp v9, v25, v240 row_newbcast:0 row_mask:0xf bank_mask:0xf
    v_dot2c_f32_bf16_dpp v10, v24, v241 row_newbcast:0 row_mask:0xf bank_mask:0xf
    v_dot2c_f32_bf16_dpp v11, v25, v241 row_newbcast:0 row_mask:0xf bank_mask:0xf
    v_dot2c_f32_bf16_dpp v12, v24, v242 row_newbcast:0 row_mask:0xf bank_mask:0xf
    v_dot2c_f32_bf16_dpp v13, v25, v242 row_newbcast:0 row_mask:0xf bank_mask:0xf
    v_dot2c_f32_bf16_dpp v14, v24, v243 row_newbcast:0 row_mask:0xf bank_mask:0xf
    v_dot2c_f32_bf16_dpp v15, v25, v243 row_newbcast:0 row_mask:0xf bank_mask:0xf
    v_dot2c_f32_bf16_dpp v8, v24, v244 row_newbcast:8 row_mask:0xf bank_mask:0xf
    v_dot2c_f32_bf16_dpp v9, v25, v244 row_newbcast:8 row_mask:0xf bank_mask:0xf
    v_dot2c_f32_bf16_dpp v10, v24, v245 row_newbcast:8 row_mask:0xf bank_mask:0xf
    v_dot2c_f32_bf16_dpp v11, v25, v245 row_newbcast:8 row_mask:0xf bank_mask:0xf
    v_dot2c_f32_bf16_dpp v12, v24, v246 row_newbcast:8 row_mask:0xf bank_mask:0xf
    v_dot2c_f32_bf16_dpp v13, v25, v246 row_newbcast:8 row_mask:0xf bank_mask:0xf
    v_dot2c_f32_bf16_dpp v14, v24, v247 row_newbcast:8 row_mask:0xf bank_mask:0xf
    v_dot2c_f32_bf16_dpp v15, v25, v247 row_newbcast:8 row_mask:0xf bank_mask:0xf
    v_dot2c_f32_bf16_dpp v8, v24, v248 row_newbcast:4 row_mask:0xf bank_mask:0xf
    v_dot2c_f32_bf16_dpp v9, v25, v248 row_newbcast:4 row_mask:0xf bank_mask:0xf
    v_dot2c_f32_bf16_dpp v10, v24, v249 row_newbcast:4 row_mask:0xf bank_mask:0xf
    v_dot2c_f32_bf16_dpp v11, v25, v249 row_newbcast:4 row_mask:0xf bank_mask:0xf
    v_dot2c_f32_bf16_dpp v12, v24, v250 row_newbcast:4 row_mask:0xf bank_mask:0xf
    v_dot2c_f32_bf16_dpp v13, v25, v250 row_newbcast:4 row_mask:0xf bank_mask:0xf
    v_dot2c_f32_bf16_dpp v14, v24, v251 row_newbcast:4 row_mask:0xf bank_mask:0xf
    v_dot2c_f32_bf16_dpp v15, v25, v251 row_newbcast:4 row_mask:0xf bank_mask:0xf
    v_dot2c_f32_bf16_dpp v8, v24, v252 row_newbcast:12 row_mask:0xf bank_mask:0xf
    v_dot2c_f32_bf16_dpp v9, v25, v252 row_newbcast:12 row_mask:0xf bank_mask:0xf
    v_dot2c_f32_bf16_dpp v10, v24, v253 row_newbcast:12 row_mask:0xf bank_mask:0xf
    v_dot2c_f32_bf16_dpp v11, v25, v253 row_newbcast:12 row_mask:0xf bank_mask:0xf
    v_dot2c_f32_bf16_dpp v12, v24, v254 row_newbcast:12 row_mask:0xf bank_mask:0xf
    v_dot2c_f32_bf16_dpp v13, v25, v254 row_newbcast:12 row_mask:0xf bank_mask:0xf
    v_dot2c_f32_bf16_dpp v14, v24, v255 row_newbcast:12 row_mask:0xf bank_mask:0xf
    v_dot2c_f32_bf16_dpp v15, v25, v255 row_newbcast:12 row_mask:0xf bank_mask:0xf
    buffer_load_dwordx4 v[240:243], v1, s[8:11], s43 offen offset:0 sc0 sc1 nt
    buffer_load_dwordx4 v[244:247], v1, s[8:11], s43 offen offset:1024 sc0 sc1 nt
    buffer_load_dwordx4 v[248:251], v1, s[8:11], s43 offen offset:2048 sc0 sc1 nt
    buffer_load_dwordx4 v[252:255], v1, s[8:11], s43 offen offset:3072 sc0 sc1 nt
    s_setprio 0
    s_waitcnt vmcnt(28)
    v_dot2_f32_bf16 v20, v40, v16, 0
    v_dot2_f32_bf16 v21, v44, v16, 0
    v_dot2_f32_bf16 v22, v48, v16, 0
    v_dot2_f32_bf16 v23, v52, v16, 0
    v_dot2c_f32_bf16 v20, v41, v17
    v_dot2c_f32_bf16 v21, v45, v17
    v_dot2c_f32_bf16 v22, v49, v17
    v_dot2c_f32_bf16 v23, v53, v17
    v_dot2c_f32_bf16 v20, v42, v18
    v_dot2c_f32_bf16 v21, v46, v18
    v_dot2c_f32_bf16 v22, v50, v18
    v_dot2c_f32_bf16 v23, v54, v18
    v_dot2c_f32_bf16 v20, v43, v19
    v_dot2c_f32_bf16 v21, v47, v19
    v_dot2c_f32_bf16 v22, v51, v19
    v_dot2c_f32_bf16 v23, v55, v19
    s_add_u32 s43, s43, 32768
    buffer_load_dwordx4 v[40:43], v1, s[4:7], s43 offen offset:0 sc0 sc1 nt
    buffer_load_dwordx4 v[44:47], v1, s[4:7], s43 offen offset:1024 sc0 sc1 nt
    buffer_load_dwordx4 v[48:51], v1, s[4:7], s43 offen offset:2048 sc0 sc1 nt
    buffer_load_dwordx4 v[52:55], v1, s[4:7], s43 offen offset:3072 sc0 sc1 nt
    v_add_f32_dpp v20, v20, v20 row_ror:8 row_mask:0xf bank_mask:0x3
    v_add_f32_dpp v22, v22, v22 row_ror:8 row_mask:0xf bank_mask:0x3
    s_nop 0
    v_add_f32_dpp v20, v21, v21 row_ror:8 row_mask:0xf bank_mask:0xc
    v_add_f32_dpp v22, v23, v23 row_ror:8 row_mask:0xf bank_mask:0xc
    s_nop 0
    v_add_f32_dpp v20, v20, v20 row_half_mirror row_mask:0xf bank_mask:0x5
    s_nop 1
    v_add_f32_dpp v20, v22, v22 row_half_mirror row_mask:0xf bank_mask:0xa
    s_nop 1
    v_add_f32_dpp v20, v20, v20 quad_perm:[1,0,3,2] row_mask:0xf bank_mask:0xf
    s_nop 1
    v_add_f32_dpp v20, v20, v20 quad_perm:[2,3,0,1] row_mask:0xf bank_mask:0xf
    v_cvt_pk_bf16_f32 v20, v20, v20
    v_and_b32 v20, s50, v20
    v_mul_f32 v20, s51, v20
    v_cvt_pk_bf16_f32 v20, v20, v20
    v_and_b32 v20, s50, v20
    s_nop 1
    v_max_f32_dpp v21, v20, v20 row_ror:4 row_mask:0xf bank_mask:0xf
    s_nop 1
    v_max_f32_dpp v21, v21, v21 row_ror:8 row_mask:0xf bank_mask:0xf
    v_max_f32 v21, v21, v5
    v_sub_f32 v22, v5, v21
    v_sub_f32 v20, v20, v21
    v_mov_b32 v5, v21
    v_mul_f32 v22, s52, v22
    v_mul_f32 v20, s52, v20
    v_exp_f32 v26, v22
    v_exp_f32 v20, v20
    v_pk_mul_f32 v[8:9], v[8:9], v[26:27] op_sel_hi:[1,0]
    v_pk_mul_f32 v[10:11], v[10:11], v[26:27] op_sel_hi:[1,0]
    v_pk_mul_f32 v[12:13], v[12:13], v[26:27] op_sel_hi:[1,0]
    v_pk_mul_f32 v[14:15], v[14:15], v[26:27] op_sel_hi:[1,0]
    v_cvt_pk_bf16_f32 v24, v20, 0
    v_cvt_pk_bf16_f32 v25, 0, v20
    v_fma_f32 v6, v6, v26, v20
    s_waitcnt vmcnt(28)
    v_dot2c_f32_bf16_dpp v8, v24, v56 row_newbcast:0 row_mask:0xf bank_mask:0xf
    v_dot2c_f32_bf16_dpp v9, v25, v56 row_newbcast:0 row_mask:0xf bank_mask:0xf
    v_dot2c_f32_bf16_dpp v10, v24, v57 row_newbcast:0 row_mask:0xf bank_mask:0xf
    v_dot2c_f32_bf16_dpp v11, v25, v57 row_newbcast:0 row_mask:0xf bank_mask:0xf
    v_dot2c_f32_bf16_dpp v12, v24, v58 row_newbcast:0 row_mask:0xf bank_mask:0xf
    v_dot2c_f32_bf16_dpp v13, v25, v58 row_newbcast:0 row_mask:0xf bank_mask:0xf
    v_dot2c_f32_bf16_dpp v14, v24, v59 row_newbcast:0 row_mask:0xf bank_mask:0xf
    v_dot2c_f32_bf16_dpp v15, v25, v59 row_newbcast:0 row_mask:0xf bank_mask:0xf
    v_dot2c_f32_bf16_dpp v8, v24, v60 row_newbcast:8 row_mask:0xf bank_mask:0xf
    v_dot2c_f32_bf16_dpp v9, v25, v60 row_newbcast:8 row_mask:0xf bank_mask:0xf
    v_dot2c_f32_bf16_dpp v10, v24, v61 row_newbcast:8 row_mask:0xf bank_mask:0xf
    v_dot2c_f32_bf16_dpp v11, v25, v61 row_newbcast:8 row_mask:0xf bank_mask:0xf
    v_dot2c_f32_bf16_dpp v12, v24, v62 row_newbcast:8 row_mask:0xf bank_mask:0xf
    v_dot2c_f32_bf16_dpp v13, v25, v62 row_newbcast:8 row_mask:0xf bank_mask:0xf
    v_dot2c_f32_bf16_dpp v14, v24, v63 row_newbcast:8 row_mask:0xf bank_mask:0xf
    v_dot2c_f32_bf16_dpp v15, v25, v63 row_newbcast:8 row_mask:0xf bank_mask:0xf
    v_dot2c_f32_bf16_dpp v8, v24, v64 row_newbcast:4 row_mask:0xf bank_mask:0xf
    v_dot2c_f32_bf16_dpp v9, v25, v64 row_newbcast:4 row_mask:0xf bank_mask:0xf
    v_dot2c_f32_bf16_dpp v10, v24, v65 row_newbcast:4 row_mask:0xf bank_mask:0xf
    v_dot2c_f32_bf16_dpp v11, v25, v65 row_newbcast:4 row_mask:0xf bank_mask:0xf
    v_dot2c_f32_bf16_dpp v12, v24, v66 row_newbcast:4 row_mask:0xf bank_mask:0xf
    v_dot2c_f32_bf16_dpp v13, v25, v66 row_newbcast:4 row_mask:0xf bank_mask:0xf
    v_dot2c_f32_bf16_dpp v14, v24, v67 row_newbcast:4 row_mask:0xf bank_mask:0xf
    v_dot2c_f32_bf16_dpp v15, v25, v67 row_newbcast:4 row_mask:0xf bank_mask:0xf
    v_dot2c_f32_bf16_dpp v8, v24, v68 row_newbcast:12 row_mask:0xf bank_mask:0xf
    v_dot2c_f32_bf16_dpp v9, v25, v68 row_newbcast:12 row_mask:0xf bank_mask:0xf
    v_dot2c_f32_bf16_dpp v10, v24, v69 row_newbcast:12 row_mask:0xf bank_mask:0xf
    v_dot2c_f32_bf16_dpp v11, v25, v69 row_newbcast:12 row_mask:0xf bank_mask:0xf
    v_dot2c_f32_bf16_dpp v12, v24, v70 row_newbcast:12 row_mask:0xf bank_mask:0xf
    v_dot2c_f32_bf16_dpp v13, v25, v70 row_newbcast:12 row_mask:0xf bank_mask:0xf
    v_dot2c_f32_bf16_dpp v14, v24, v71 row_newbcast:12 row_mask:0xf bank_mask:0xf
    v_dot2c_f32_bf16_dpp v15, v25, v71 row_newbcast:12 row_mask:0xf bank_mask:0xf
    buffer_load_dwordx4 v[56:59], v1, s[8:11], s43 offen offset:0 sc0 sc1 nt
    buffer_load_dwordx4 v[60:63], v1, s[8:11], s43 offen offset:1024 sc0 sc1 nt
    buffer_load_dwordx4 v[64:67], v1, s[8:11], s43 offen offset:2048 sc0 sc1 nt
    buffer_load_dwordx4 v[68:71], v1, s[8:11], s43 offen offset:3072 sc0 sc1 nt
    s_waitcnt vmcnt(28)
    v_dot2_f32_bf16 v20, v72, v16, 0
    v_dot2_f32_bf16 v21, v76, v16, 0
    v_dot2_f32_bf16 v22, v80, v16, 0
    v_dot2_f32_bf16 v23, v84, v16, 0
    v_dot2c_f32_bf16 v20, v73, v17
    v_dot2c_f32_bf16 v21, v77, v17
    v_dot2c_f32_bf16 v22, v81, v17
    v_dot2c_f32_bf16 v23, v85, v17
    v_dot2c_f32_bf16 v20, v74, v18
    v_dot2c_f32_bf16 v21, v78, v18
    v_dot2c_f32_bf16 v22, v82, v18
    v_dot2c_f32_bf16 v23, v86, v18
    v_dot2c_f32_bf16 v20, v75, v19
    v_dot2c_f32_bf16 v21, v79, v19
    v_dot2c_f32_bf16 v22, v83, v19
    v_dot2c_f32_bf16 v23, v87, v19
    s_add_u32 s43, s43, 32768
    buffer_load_dwordx4 v[72:75], v1, s[4:7], s43 offen offset:0 sc0 sc1 nt
    buffer_load_dwordx4 v[76:79], v1, s[4:7], s43 offen offset:1024 sc0 sc1 nt
    buffer_load_dwordx4 v[80:83], v1, s[4:7], s43 offen offset:2048 sc0 sc1 nt
    buffer_load_dwordx4 v[84:87], v1, s[4:7], s43 offen offset:3072 sc0 sc1 nt
    v_add_f32_dpp v20, v20, v20 row_ror:8 row_mask:0xf bank_mask:0x3
    v_add_f32_dpp v22, v22, v22 row_ror:8 row_mask:0xf bank_mask:0x3
    s_nop 0
    v_add_f32_dpp v20, v21, v21 row_ror:8 row_mask:0xf bank_mask:0xc
    v_add_f32_dpp v22, v23, v23 row_ror:8 row_mask:0xf bank_mask:0xc
    s_nop 0
    v_add_f32_dpp v20, v20, v20 row_half_mirror row_mask:0xf bank_mask:0x5
    s_nop 1
    v_add_f32_dpp v20, v22, v22 row_half_mirror row_mask:0xf bank_mask:0xa
    s_nop 1
    v_add_f32_dpp v20, v20, v20 quad_perm:[1,0,3,2] row_mask:0xf bank_mask:0xf
    s_nop 1
    v_add_f32_dpp v20, v20, v20 quad_perm:[2,3,0,1] row_mask:0xf bank_mask:0xf
    v_cvt_pk_bf16_f32 v20, v20, v20
    v_and_b32 v20, s50, v20
    v_mul_f32 v20, s51, v20
    v_cvt_pk_bf16_f32 v20, v20, v20
    v_and_b32 v20, s50, v20
    s_nop 1
    v_max_f32_dpp v21, v20, v20 row_ror:4 row_mask:0xf bank_mask:0xf
    s_nop 1
    v_max_f32_dpp v21, v21, v21 row_ror:8 row_mask:0xf bank_mask:0xf
    v_max_f32 v21, v21, v5
    v_sub_f32 v22, v5, v21
    v_sub_f32 v20, v20, v21
    v_mov_b32 v5, v21
    v_mul_f32 v22, s52, v22
    v_mul_f32 v20, s52, v20
    v_exp_f32 v26, v22
    v_exp_f32 v20, v20
    v_pk_mul_f32 v[8:9], v[8:9], v[26:27] op_sel_hi:[1,0]
    v_pk_mul_f32 v[10:11], v[10:11], v[26:27] op_sel_hi:[1,0]
    v_pk_mul_f32 v[12:13], v[12:13], v[26:27] op_sel_hi:[1,0]
    v_pk_mul_f32 v[14:15], v[14:15], v[26:27] op_sel_hi:[1,0]
    v_cvt_pk_bf16_f32 v24, v20, 0
    v_cvt_pk_bf16_f32 v25, 0, v20
    v_fma_f32 v6, v6, v26, v20
    s_waitcnt vmcnt(28)
    v_dot2c_f32_bf16_dpp v8, v24, v88 row_newbcast:0 row_mask:0xf bank_mask:0xf
    v_dot2c_f32_bf16_dpp v9, v25, v88 row_newbcast:0 row_mask:0xf bank_mask:0xf
    v_dot2c_f32_bf16_dpp v10, v24, v89 row_newbcast:0 row_mask:0xf bank_mask:0xf
    v_dot2c_f32_bf16_dpp v11, v25, v89 row_newbcast:0 row_mask:0xf bank_mask:0xf
    v_dot2c_f32_bf16_dpp v12, v24, v90 row_newbcast:0 row_mask:0xf bank_mask:0xf
    v_dot2c_f32_bf16_dpp v13, v25, v90 row_newbcast:0 row_mask:0xf bank_mask:0xf
    v_dot2c_f32_bf16_dpp v14, v24, v91 row_newbcast:0 row_mask:0xf bank_mask:0xf
    v_dot2c_f32_bf16_dpp v15, v25, v91 row_newbcast:0 row_mask:0xf bank_mask:0xf
    v_dot2c_f32_bf16_dpp v8, v24, v92 row_newbcast:8 row_mask:0xf bank_mask:0xf
    v_dot2c_f32_bf16_dpp v9, v25, v92 row_newbcast:8 row_mask:0xf bank_mask:0xf
    v_dot2c_f32_bf16_dpp v10, v24, v93 row_newbcast:8 row_mask:0xf bank_mask:0xf
    v_dot2c_f32_bf16_dpp v11, v25, v93 row_newbcast:8 row_mask:0xf bank_mask:0xf
    v_dot2c_f32_bf16_dpp v12, v24, v94 row_newbcast:8 row_mask:0xf bank_mask:0xf
    v_dot2c_f32_bf16_dpp v13, v25, v94 row_newbcast:8 row_mask:0xf bank_mask:0xf
    v_dot2c_f32_bf16_dpp v14, v24, v95 row_newbcast:8 row_mask:0xf bank_mask:0xf
    v_dot2c_f32_bf16_dpp v15, v25, v95 row_newbcast:8 row_mask:0xf bank_mask:0xf
    v_dot2c_f32_bf16_dpp v8, v24, v96 row_newbcast:4 row_mask:0xf bank_mask:0xf
    v_dot2c_f32_bf16_dpp v9, v25, v96 row_newbcast:4 row_mask:0xf bank_mask:0xf
    v_dot2c_f32_bf16_dpp v10, v24, v97 row_newbcast:4 row_mask:0xf bank_mask:0xf
    v_dot2c_f32_bf16_dpp v11, v25, v97 row_newbcast:4 row_mask:0xf bank_mask:0xf
    v_dot2c_f32_bf16_dpp v12, v24, v98 row_newbcast:4 row_mask:0xf bank_mask:0xf
    v_dot2c_f32_bf16_dpp v13, v25, v98 row_newbcast:4 row_mask:0xf bank_mask:0xf
    v_dot2c_f32_bf16_dpp v14, v24, v99 row_newbcast:4 row_mask:0xf bank_mask:0xf
    v_dot2c_f32_bf16_dpp v15, v25, v99 row_newbcast:4 row_mask:0xf bank_mask:0xf
    v_dot2c_f32_bf16_dpp v8, v24, v100 row_newbcast:12 row_mask:0xf bank_mask:0xf
    v_dot2c_f32_bf16_dpp v9, v25, v100 row_newbcast:12 row_mask:0xf bank_mask:0xf
    v_dot2c_f32_bf16_dpp v10, v24, v101 row_newbcast:12 row_mask:0xf bank_mask:0xf
    v_dot2c_f32_bf16_dpp v11, v25, v101 row_newbcast:12 row_mask:0xf bank_mask:0xf
    v_dot2c_f32_bf16_dpp v12, v24, v102 row_newbcast:12 row_mask:0xf bank_mask:0xf
    v_dot2c_f32_bf16_dpp v13, v25, v102 row_newbcast:12 row_mask:0xf bank_mask:0xf
    v_dot2c_f32_bf16_dpp v14, v24, v103 row_newbcast:12 row_mask:0xf bank_mask:0xf
    v_dot2c_f32_bf16_dpp v15, v25, v103 row_newbcast:12 row_mask:0xf bank_mask:0xf
    buffer_load_dwordx4 v[88:91], v1, s[8:11], s43 offen offset:0 sc0 sc1 nt
    buffer_load_dwordx4 v[92:95], v1, s[8:11], s43 offen offset:1024 sc0 sc1 nt
    buffer_load_dwordx4 v[96:99], v1, s[8:11], s43 offen offset:2048 sc0 sc1 nt
    buffer_load_dwordx4 v[100:103], v1, s[8:11], s43 offen offset:3072 sc0 sc1 nt
    s_waitcnt vmcnt(28)
    v_dot2_f32_bf16 v20, v192, v16, 0
    v_dot2_f32_bf16 v21, v196, v16, 0
    v_dot2_f32_bf16 v22, v200, v16, 0
    v_dot2_f32_bf16 v23, v204, v16, 0
    v_dot2c_f32_bf16 v20, v193, v17
    v_dot2c_f32_bf16 v21, v197, v17
    v_dot2c_f32_bf16 v22, v201, v17
    v_dot2c_f32_bf16 v23, v205, v17
    v_dot2c_f32_bf16 v20, v194, v18
    v_dot2c_f32_bf16 v21, v198, v18
    v_dot2c_f32_bf16 v22, v202, v18
    v_dot2c_f32_bf16 v23, v206, v18
    v_dot2c_f32_bf16 v20, v195, v19
    v_dot2c_f32_bf16 v21, v199, v19
    v_dot2c_f32_bf16 v22, v203, v19
    v_dot2c_f32_bf16 v23, v207, v19
    s_add_u32 s43, s43, 32768
    buffer_load_dwordx4 v[192:195], v1, s[4:7], s43 offen offset:0 sc0 sc1 nt
    buffer_load_dwordx4 v[196:199], v1, s[4:7], s43 offen offset:1024 sc0 sc1 nt
    buffer_load_dwordx4 v[200:203], v1, s[4:7], s43 offen offset:2048 sc0 sc1 nt
    buffer_load_dwordx4 v[204:207], v1, s[4:7], s43 offen offset:3072 sc0 sc1 nt
    v_add_f32_dpp v20, v20, v20 row_ror:8 row_mask:0xf bank_mask:0x3
    v_add_f32_dpp v22, v22, v22 row_ror:8 row_mask:0xf bank_mask:0x3
    s_nop 0
    v_add_f32_dpp v20, v21, v21 row_ror:8 row_mask:0xf bank_mask:0xc
    v_add_f32_dpp v22, v23, v23 row_ror:8 row_mask:0xf bank_mask:0xc
    s_nop 0
    v_add_f32_dpp v20, v20, v20 row_half_mirror row_mask:0xf bank_mask:0x5
    s_nop 1
    v_add_f32_dpp v20, v22, v22 row_half_mirror row_mask:0xf bank_mask:0xa
    s_nop 1
    v_add_f32_dpp v20, v20, v20 quad_perm:[1,0,3,2] row_mask:0xf bank_mask:0xf
    s_nop 1
    v_add_f32_dpp v20, v20, v20 quad_perm:[2,3,0,1] row_mask:0xf bank_mask:0xf
    v_cvt_pk_bf16_f32 v20, v20, v20
    v_and_b32 v20, s50, v20
    v_mul_f32 v20, s51, v20
    v_cvt_pk_bf16_f32 v20, v20, v20
    v_and_b32 v20, s50, v20
    s_nop 1
    v_max_f32_dpp v21, v20, v20 row_ror:4 row_mask:0xf bank_mask:0xf
    s_nop 1
    v_max_f32_dpp v21, v21, v21 row_ror:8 row_mask:0xf bank_mask:0xf
    v_max_f32 v21, v21, v5
    v_sub_f32 v22, v5, v21
    v_sub_f32 v20, v20, v21
    v_mov_b32 v5, v21
    v_mul_f32 v22, s52, v22
    v_mul_f32 v20, s52, v20
    v_exp_f32 v26, v22
    v_exp_f32 v20, v20
    v_pk_mul_f32 v[8:9], v[8:9], v[26:27] op_sel_hi:[1,0]
    v_pk_mul_f32 v[10:11], v[10:11], v[26:27] op_sel_hi:[1,0]
    v_pk_mul_f32 v[12:13], v[12:13], v[26:27] op_sel_hi:[1,0]
    v_pk_mul_f32 v[14:15], v[14:15], v[26:27] op_sel_hi:[1,0]
    v_cvt_pk_bf16_f32 v24, v20, 0
    v_cvt_pk_bf16_f32 v25, 0, v20
    v_fma_f32 v6, v6, v26, v20
    s_waitcnt vmcnt(28)
    v_dot2c_f32_bf16_dpp v8, v24, v208 row_newbcast:0 row_mask:0xf bank_mask:0xf
    v_dot2c_f32_bf16_dpp v9, v25, v208 row_newbcast:0 row_mask:0xf bank_mask:0xf
    v_dot2c_f32_bf16_dpp v10, v24, v209 row_newbcast:0 row_mask:0xf bank_mask:0xf
    v_dot2c_f32_bf16_dpp v11, v25, v209 row_newbcast:0 row_mask:0xf bank_mask:0xf
    v_dot2c_f32_bf16_dpp v12, v24, v210 row_newbcast:0 row_mask:0xf bank_mask:0xf
    v_dot2c_f32_bf16_dpp v13, v25, v210 row_newbcast:0 row_mask:0xf bank_mask:0xf
    v_dot2c_f32_bf16_dpp v14, v24, v211 row_newbcast:0 row_mask:0xf bank_mask:0xf
    v_dot2c_f32_bf16_dpp v15, v25, v211 row_newbcast:0 row_mask:0xf bank_mask:0xf
    v_dot2c_f32_bf16_dpp v8, v24, v212 row_newbcast:8 row_mask:0xf bank_mask:0xf
    v_dot2c_f32_bf16_dpp v9, v25, v212 row_newbcast:8 row_mask:0xf bank_mask:0xf
    v_dot2c_f32_bf16_dpp v10, v24, v213 row_newbcast:8 row_mask:0xf bank_mask:0xf
    v_dot2c_f32_bf16_dpp v11, v25, v213 row_newbcast:8 row_mask:0xf bank_mask:0xf
    v_dot2c_f32_bf16_dpp v12, v24, v214 row_newbcast:8 row_mask:0xf bank_mask:0xf
    v_dot2c_f32_bf16_dpp v13, v25, v214 row_newbcast:8 row_mask:0xf bank_mask:0xf
    v_dot2c_f32_bf16_dpp v14, v24, v215 row_newbcast:8 row_mask:0xf bank_mask:0xf
    v_dot2c_f32_bf16_dpp v15, v25, v215 row_newbcast:8 row_mask:0xf bank_mask:0xf
    v_dot2c_f32_bf16_dpp v8, v24, v216 row_newbcast:4 row_mask:0xf bank_mask:0xf
    v_dot2c_f32_bf16_dpp v9, v25, v216 row_newbcast:4 row_mask:0xf bank_mask:0xf
    v_dot2c_f32_bf16_dpp v10, v24, v217 row_newbcast:4 row_mask:0xf bank_mask:0xf
    v_dot2c_f32_bf16_dpp v11, v25, v217 row_newbcast:4 row_mask:0xf bank_mask:0xf
    v_dot2c_f32_bf16_dpp v12, v24, v218 row_newbcast:4 row_mask:0xf bank_mask:0xf
    v_dot2c_f32_bf16_dpp v13, v25, v218 row_newbcast:4 row_mask:0xf bank_mask:0xf
    v_dot2c_f32_bf16_dpp v14, v24, v219 row_newbcast:4 row_mask:0xf bank_mask:0xf
    v_dot2c_f32_bf16_dpp v15, v25, v219 row_newbcast:4 row_mask:0xf bank_mask:0xf
    v_dot2c_f32_bf16_dpp v8, v24, v220 row_newbcast:12 row_mask:0xf bank_mask:0xf
    v_dot2c_f32_bf16_dpp v9, v25, v220 row_newbcast:12 row_mask:0xf bank_mask:0xf
    v_dot2c_f32_bf16_dpp v10, v24, v221 row_newbcast:12 row_mask:0xf bank_mask:0xf
    v_dot2c_f32_bf16_dpp v11, v25, v221 row_newbcast:12 row_mask:0xf bank_mask:0xf
    v_dot2c_f32_bf16_dpp v12, v24, v222 row_newbcast:12 row_mask:0xf bank_mask:0xf
    v_dot2c_f32_bf16_dpp v13, v25, v222 row_newbcast:12 row_mask:0xf bank_mask:0xf
    v_dot2c_f32_bf16_dpp v14, v24, v223 row_newbcast:12 row_mask:0xf bank_mask:0xf
    v_dot2c_f32_bf16_dpp v15, v25, v223 row_newbcast:12 row_mask:0xf bank_mask:0xf
    buffer_load_dwordx4 v[208:211], v1, s[8:11], s43 offen offset:0 sc0 sc1 nt
    buffer_load_dwordx4 v[212:215], v1, s[8:11], s43 offen offset:1024 sc0 sc1 nt
    buffer_load_dwordx4 v[216:219], v1, s[8:11], s43 offen offset:2048 sc0 sc1 nt
    buffer_load_dwordx4 v[220:223], v1, s[8:11], s43 offen offset:3072 sc0 sc1 nt
    s_waitcnt vmcnt(28)
    v_dot2_f32_bf16 v20, v224, v16, 0
    v_dot2_f32_bf16 v21, v228, v16, 0
    v_dot2_f32_bf16 v22, v232, v16, 0
    v_dot2_f32_bf16 v23, v236, v16, 0
    v_dot2c_f32_bf16 v20, v225, v17
    v_dot2c_f32_bf16 v21, v229, v17
    v_dot2c_f32_bf16 v22, v233, v17
    v_dot2c_f32_bf16 v23, v237, v17
    v_dot2c_f32_bf16 v20, v226, v18
    v_dot2c_f32_bf16 v21, v230, v18
    v_dot2c_f32_bf16 v22, v234, v18
    v_dot2c_f32_bf16 v23, v238, v18
    v_dot2c_f32_bf16 v20, v227, v19
    v_dot2c_f32_bf16 v21, v231, v19
    v_dot2c_f32_bf16 v22, v235, v19
    v_dot2c_f32_bf16 v23, v239, v19
    s_add_u32 s43, s43, 32768
    buffer_load_dwordx4 v[224:227], v1, s[4:7], s43 offen offset:0 sc0 sc1 nt
    buffer_load_dwordx4 v[228:231], v1, s[4:7], s43 offen offset:1024 sc0 sc1 nt
    buffer_load_dwordx4 v[232:235], v1, s[4:7], s43 offen offset:2048 sc0 sc1 nt
    buffer_load_dwordx4 v[236:239], v1, s[4:7], s43 offen offset:3072 sc0 sc1 nt
    v_add_f32_dpp v20, v20, v20 row_ror:8 row_mask:0xf bank_mask:0x3
    v_add_f32_dpp v22, v22, v22 row_ror:8 row_mask:0xf bank_mask:0x3
    s_nop 0
    v_add_f32_dpp v20, v21, v21 row_ror:8 row_mask:0xf bank_mask:0xc
    v_add_f32_dpp v22, v23, v23 row_ror:8 row_mask:0xf bank_mask:0xc
    s_nop 0
    v_add_f32_dpp v20, v20, v20 row_half_mirror row_mask:0xf bank_mask:0x5
    s_nop 1
    v_add_f32_dpp v20, v22, v22 row_half_mirror row_mask:0xf bank_mask:0xa
    s_nop 1
    v_add_f32_dpp v20, v20, v20 quad_perm:[1,0,3,2] row_mask:0xf bank_mask:0xf
    s_nop 1
    v_add_f32_dpp v20, v20, v20 quad_perm:[2,3,0,1] row_mask:0xf bank_mask:0xf
    v_cvt_pk_bf16_f32 v20, v20, v20
    v_and_b32 v20, s50, v20
    v_mul_f32 v20, s51, v20
    v_cvt_pk_bf16_f32 v20, v20, v20
    v_and_b32 v20, s50, v20
    s_nop 1
    v_max_f32_dpp v21, v20, v20 row_ror:4 row_mask:0xf bank_mask:0xf
    s_nop 1
    v_max_f32_dpp v21, v21, v21 row_ror:8 row_mask:0xf bank_mask:0xf
    v_max_f32 v21, v21, v5
    v_sub_f32 v22, v5, v21
    v_sub_f32 v20, v20, v21
    v_mov_b32 v5, v21
    v_mul_f32 v22, s52, v22
    v_mul_f32 v20, s52, v20
    v_exp_f32 v26, v22
    v_exp_f32 v20, v20
    v_pk_mul_f32 v[8:9], v[8:9], v[26:27] op_sel_hi:[1,0]
    v_pk_mul_f32 v[10:11], v[10:11], v[26:27] op_sel_hi:[1,0]
    v_pk_mul_f32 v[12:13], v[12:13], v[26:27] op_sel_hi:[1,0]
    v_pk_mul_f32 v[14:15], v[14:15], v[26:27] op_sel_hi:[1,0]
    v_cvt_pk_bf16_f32 v24, v20, 0
    v_cvt_pk_bf16_f32 v25, 0, v20
    v_fma_f32 v6, v6, v26, v20
    s_waitcnt vmcnt(28)
    v_dot2c_f32_bf16_dpp v8, v24, v240 row_newbcast:0 row_mask:0xf bank_mask:0xf
    v_dot2c_f32_bf16_dpp v9, v25, v240 row_newbcast:0 row_mask:0xf bank_mask:0xf
    v_dot2c_f32_bf16_dpp v10, v24, v241 row_newbcast:0 row_mask:0xf bank_mask:0xf
    v_dot2c_f32_bf16_dpp v11, v25, v241 row_newbcast:0 row_mask:0xf bank_mask:0xf
    v_dot2c_f32_bf16_dpp v12, v24, v242 row_newbcast:0 row_mask:0xf bank_mask:0xf
    v_dot2c_f32_bf16_dpp v13, v25, v242 row_newbcast:0 row_mask:0xf bank_mask:0xf
    v_dot2c_f32_bf16_dpp v14, v24, v243 row_newbcast:0 row_mask:0xf bank_mask:0xf
    v_dot2c_f32_bf16_dpp v15, v25, v243 row_newbcast:0 row_mask:0xf bank_mask:0xf
    v_dot2c_f32_bf16_dpp v8, v24, v244 row_newbcast:8 row_mask:0xf bank_mask:0xf
    v_dot2c_f32_bf16_dpp v9, v25, v244 row_newbcast:8 row_mask:0xf bank_mask:0xf
    v_dot2c_f32_bf16_dpp v10, v24, v245 row_newbcast:8 row_mask:0xf bank_mask:0xf
    v_dot2c_f32_bf16_dpp v11, v25, v245 row_newbcast:8 row_mask:0xf bank_mask:0xf
    v_dot2c_f32_bf16_dpp v12, v24, v246 row_newbcast:8 row_mask:0xf bank_mask:0xf
    v_dot2c_f32_bf16_dpp v13, v25, v246 row_newbcast:8 row_mask:0xf bank_mask:0xf
    v_dot2c_f32_bf16_dpp v14, v24, v247 row_newbcast:8 row_mask:0xf bank_mask:0xf
    v_dot2c_f32_bf16_dpp v15, v25, v247 row_newbcast:8 row_mask:0xf bank_mask:0xf
    v_dot2c_f32_bf16_dpp v8, v24, v248 row_newbcast:4 row_mask:0xf bank_mask:0xf
    v_dot2c_f32_bf16_dpp v9, v25, v248 row_newbcast:4 row_mask:0xf bank_mask:0xf
    v_dot2c_f32_bf16_dpp v10, v24, v249 row_newbcast:4 row_mask:0xf bank_mask:0xf
    v_dot2c_f32_bf16_dpp v11, v25, v249 row_newbcast:4 row_mask:0xf bank_mask:0xf
    v_dot2c_f32_bf16_dpp v12, v24, v250 row_newbcast:4 row_mask:0xf bank_mask:0xf
    v_dot2c_f32_bf16_dpp v13, v25, v250 row_newbcast:4 row_mask:0xf bank_mask:0xf
    v_dot2c_f32_bf16_dpp v14, v24, v251 row_newbcast:4 row_mask:0xf bank_mask:0xf
    v_dot2c_f32_bf16_dpp v15, v25, v251 row_newbcast:4 row_mask:0xf bank_mask:0xf
    v_dot2c_f32_bf16_dpp v8, v24, v252 row_newbcast:12 row_mask:0xf bank_mask:0xf
    v_dot2c_f32_bf16_dpp v9, v25, v252 row_newbcast:12 row_mask:0xf bank_mask:0xf
    v_dot2c_f32_bf16_dpp v10, v24, v253 row_newbcast:12 row_mask:0xf bank_mask:0xf
    v_dot2c_f32_bf16_dpp v11, v25, v253 row_newbcast:12 row_mask:0xf bank_mask:0xf
    v_dot2c_f32_bf16_dpp v12, v24, v254 row_newbcast:12 row_mask:0xf bank_mask:0xf
    v_dot2c_f32_bf16_dpp v13, v25, v254 row_newbcast:12 row_mask:0xf bank_mask:0xf
    v_dot2c_f32_bf16_dpp v14, v24, v255 row_newbcast:12 row_mask:0xf bank_mask:0xf
    v_dot2c_f32_bf16_dpp v15, v25, v255 row_newbcast:12 row_mask:0xf bank_mask:0xf
    buffer_load_dwordx4 v[240:243], v1, s[8:11], s43 offen offset:0 sc0 sc1 nt
    buffer_load_dwordx4 v[244:247], v1, s[8:11], s43 offen offset:1024 sc0 sc1 nt
    buffer_load_dwordx4 v[248:251], v1, s[8:11], s43 offen offset:2048 sc0 sc1 nt
    buffer_load_dwordx4 v[252:255], v1, s[8:11], s43 offen offset:3072 sc0 sc1 nt
    s_waitcnt vmcnt(28)
    v_dot2_f32_bf16 v20, v40, v16, 0
    v_dot2_f32_bf16 v21, v44, v16, 0
    v_dot2_f32_bf16 v22, v48, v16, 0
    v_dot2_f32_bf16 v23, v52, v16, 0
    v_dot2c_f32_bf16 v20, v41, v17
    v_dot2c_f32_bf16 v21, v45, v17
    v_dot2c_f32_bf16 v22, v49, v17
    v_dot2c_f32_bf16 v23, v53, v17
    v_dot2c_f32_bf16 v20, v42, v18
    v_dot2c_f32_bf16 v21, v46, v18
    v_dot2c_f32_bf16 v22, v50, v18
    v_dot2c_f32_bf16 v23, v54, v18
    v_dot2c_f32_bf16 v20, v43, v19
    v_dot2c_f32_bf16 v21, v47, v19
    v_dot2c_f32_bf16 v22, v51, v19
    v_dot2c_f32_bf16 v23, v55, v19
    v_add_f32_dpp v20, v20, v20 row_ror:8 row_mask:0xf bank_mask:0x3
    s_nop 0
    v_add_f32_dpp v22, v22, v22 row_ror:8 row_mask:0xf bank_mask:0x3
    v_add_f32_dpp v20, v21, v21 row_ror:8 row_mask:0xf bank_mask:0xc
    s_nop 0
    v_add_f32_dpp v22, v23, v23 row_ror:8 row_mask:0xf bank_mask:0xc
    v_add_f32_dpp v20, v20, v20 row_half_mirror row_mask:0xf bank_mask:0x5
    s_nop 1
    v_add_f32_dpp v20, v22, v22 row_half_mirror row_mask:0xf bank_mask:0xa
    s_nop 1
    v_add_f32_dpp v20, v20, v20 quad_perm:[1,0,3,2] row_mask:0xf bank_mask:0xf
    s_nop 1
    v_add_f32_dpp v20, v20, v20 quad_perm:[2,3,0,1] row_mask:0xf bank_mask:0xf
    v_cvt_pk_bf16_f32 v20, v20, v20
    v_and_b32 v20, s50, v20
    v_mul_f32 v20, s51, v20
    v_cvt_pk_bf16_f32 v20, v20, v20
    v_and_b32 v20, s50, v20
    s_nop 1
    v_max_f32_dpp v21, v20, v20 row_ror:4 row_mask:0xf bank_mask:0xf
    s_nop 1
    v_max_f32_dpp v21, v21, v21 row_ror:8 row_mask:0xf bank_mask:0xf
    v_max_f32 v21, v21, v5
    v_sub_f32 v22, v5, v21
    v_sub_f32 v20, v20, v21
    v_mov_b32 v5, v21
    v_mul_f32 v22, s52, v22
    v_mul_f32 v20, s52, v20
    v_exp_f32 v26, v22
    v_exp_f32 v20, v20
    v_pk_mul_f32 v[8:9], v[8:9], v[26:27] op_sel_hi:[1,0]
    v_pk_mul_f32 v[10:11], v[10:11], v[26:27] op_sel_hi:[1,0]
    v_pk_mul_f32 v[12:13], v[12:13], v[26:27] op_sel_hi:[1,0]
    v_pk_mul_f32 v[14:15], v[14:15], v[26:27] op_sel_hi:[1,0]
    v_cvt_pk_bf16_f32 v24, v20, 0
    v_cvt_pk_bf16_f32 v25, 0, v20
    v_fma_f32 v6, v6, v26, v20
    s_waitcnt vmcnt(24)
    v_dot2c_f32_bf16_dpp v8, v24, v56 row_newbcast:0 row_mask:0xf bank_mask:0xf
    v_dot2c_f32_bf16_dpp v9, v25, v56 row_newbcast:0 row_mask:0xf bank_mask:0xf
    v_dot2c_f32_bf16_dpp v10, v24, v57 row_newbcast:0 row_mask:0xf bank_mask:0xf
    v_dot2c_f32_bf16_dpp v11, v25, v57 row_newbcast:0 row_mask:0xf bank_mask:0xf
    v_dot2c_f32_bf16_dpp v12, v24, v58 row_newbcast:0 row_mask:0xf bank_mask:0xf
    v_dot2c_f32_bf16_dpp v13, v25, v58 row_newbcast:0 row_mask:0xf bank_mask:0xf
    v_dot2c_f32_bf16_dpp v14, v24, v59 row_newbcast:0 row_mask:0xf bank_mask:0xf
    v_dot2c_f32_bf16_dpp v15, v25, v59 row_newbcast:0 row_mask:0xf bank_mask:0xf
    v_dot2c_f32_bf16_dpp v8, v24, v60 row_newbcast:8 row_mask:0xf bank_mask:0xf
    v_dot2c_f32_bf16_dpp v9, v25, v60 row_newbcast:8 row_mask:0xf bank_mask:0xf
    v_dot2c_f32_bf16_dpp v10, v24, v61 row_newbcast:8 row_mask:0xf bank_mask:0xf
    v_dot2c_f32_bf16_dpp v11, v25, v61 row_newbcast:8 row_mask:0xf bank_mask:0xf
    v_dot2c_f32_bf16_dpp v12, v24, v62 row_newbcast:8 row_mask:0xf bank_mask:0xf
    v_dot2c_f32_bf16_dpp v13, v25, v62 row_newbcast:8 row_mask:0xf bank_mask:0xf
    v_dot2c_f32_bf16_dpp v14, v24, v63 row_newbcast:8 row_mask:0xf bank_mask:0xf
    v_dot2c_f32_bf16_dpp v15, v25, v63 row_newbcast:8 row_mask:0xf bank_mask:0xf
    v_dot2c_f32_bf16_dpp v8, v24, v64 row_newbcast:4 row_mask:0xf bank_mask:0xf
    v_dot2c_f32_bf16_dpp v9, v25, v64 row_newbcast:4 row_mask:0xf bank_mask:0xf
    v_dot2c_f32_bf16_dpp v10, v24, v65 row_newbcast:4 row_mask:0xf bank_mask:0xf
    v_dot2c_f32_bf16_dpp v11, v25, v65 row_newbcast:4 row_mask:0xf bank_mask:0xf
    v_dot2c_f32_bf16_dpp v12, v24, v66 row_newbcast:4 row_mask:0xf bank_mask:0xf
    v_dot2c_f32_bf16_dpp v13, v25, v66 row_newbcast:4 row_mask:0xf bank_mask:0xf
    v_dot2c_f32_bf16_dpp v14, v24, v67 row_newbcast:4 row_mask:0xf bank_mask:0xf
    v_dot2c_f32_bf16_dpp v15, v25, v67 row_newbcast:4 row_mask:0xf bank_mask:0xf
    v_dot2c_f32_bf16_dpp v8, v24, v68 row_newbcast:12 row_mask:0xf bank_mask:0xf
    v_dot2c_f32_bf16_dpp v9, v25, v68 row_newbcast:12 row_mask:0xf bank_mask:0xf
    v_dot2c_f32_bf16_dpp v10, v24, v69 row_newbcast:12 row_mask:0xf bank_mask:0xf
    v_dot2c_f32_bf16_dpp v11, v25, v69 row_newbcast:12 row_mask:0xf bank_mask:0xf
    v_dot2c_f32_bf16_dpp v12, v24, v70 row_newbcast:12 row_mask:0xf bank_mask:0xf
    v_dot2c_f32_bf16_dpp v13, v25, v70 row_newbcast:12 row_mask:0xf bank_mask:0xf
    v_dot2c_f32_bf16_dpp v14, v24, v71 row_newbcast:12 row_mask:0xf bank_mask:0xf
    v_dot2c_f32_bf16_dpp v15, v25, v71 row_newbcast:12 row_mask:0xf bank_mask:0xf
    s_mov_b32 s55, 0x400000
L_go:
    ds_read_b32 v7, v2 offset:4
    s_waitcnt lgkmcnt(0)
    v_readfirstlane_b32 s47, v7
    s_nop 0
    s_cmp_lg_u32 s47, 0
    s_cbranch_scc1 L_go_ok
    s_sleep 2
    s_sub_u32 s55, s55, 1
    s_cbranch_scc0 L_go
L_go_ok:
    s_lshl_b32 s47, s40, 9
    v_add_u32 v4, s47, v33
    s_lshl_b32 s47, s40, 3
    s_add_u32 s60, s47, 135232
    v_lshlrev_b32 v28, 4, v0
    v_add_u32 v28, 139392, v28
    v_and_b32 v31, 7, v0
    v_lshlrev_b32 v31, 3, v31
    v_add_u32 v31, 135232, v31
    v_lshlrev_b32 v30, 2, v0
    v_lshrrev_b32 v7, 4, v0
    v_sub_u32 v7, v0, v7
    v_cmp_gt_u32 vcc, 160, v7
    s_nop 0
    s_mov_b64 s[66:67], vcc
    v_bfe_u32 v20, v7, 2, 1
    v_mul_u32_u24 v20, 8320, v20
    v_lshrrev_b32 v21, 3, v7
    v_lshl_add_u32 v20, v21, 4, v20
    v_and_b32 v21, 3, v7
    v_lshl_add_u32 v20, v21, 2, v20
    v_add_u32 v29, 139392, v20
    s_mov_b32 s64, 0x80008000
    s_mov_b32 s65, 0x80008000
    s_lshl_b32 s47, s41, 12
    s_add_u32 s61, s47, 0x100000
    s_add_u32 s68, s86, s61
    s_addc_u32 s69, s87, 0
    s_waitcnt vmcnt(20)
    v_dot2_f32_bf16 v20, v72, v16, 0
    v_dot2_f32_bf16 v21, v76, v16, 0
    v_dot2_f32_bf16 v22, v80, v16, 0
    v_dot2_f32_bf16 v23, v84, v16, 0
    v_dot2c_f32_bf16 v20, v73, v17
    v_dot2c_f32_bf16 v21, v77, v17
    v_dot2c_f32_bf16 v22, v81, v17
    v_dot2c_f32_bf16 v23, v85, v17
    v_dot2c_f32_bf16 v20, v74, v18
    v_dot2c_f32_bf16 v21, v78, v18
    v_dot2c_f32_bf16 v22, v82, v18
    v_dot2c_f32_bf16 v23, v86, v18
    v_dot2c_f32_bf16 v20, v75, v19
    v_dot2c_f32_bf16 v21, v79, v19
    v_dot2c_f32_bf16 v22, v83, v19
    v_dot2c_f32_bf16 v23, v87, v19
    v_add_f32_dpp v20, v20, v20 row_ror:8 row_mask:0xf bank_mask:0x3
    s_nop 0
    v_add_f32_dpp v22, v22, v22 row_ror:8 row_mask:0xf bank_mask:0x3
    v_add_f32_dpp v20, v21, v21 row_ror:8 row_mask:0xf bank_mask:0xc
    s_nop 0
    v_add_f32_dpp v22, v23, v23 row_ror:8 row_mask:0xf bank_mask:0xc
    v_add_f32_dpp v20, v20, v20 row_half_mirror row_mask:0xf bank_mask:0x5
    s_nop 1
    v_add_f32_dpp v20, v22, v22 row_half_mirror row_mask:0xf bank_mask:0xa
    s_nop 1
    v_add_f32_dpp v20, v20, v20 quad_perm:[1,0,3,2] row_mask:0xf bank_mask:0xf
    s_nop 1
    v_add_f32_dpp v20, v20, v20 quad_perm:[2,3,0,1] row_mask:0xf bank_mask:0xf
    v_cvt_pk_bf16_f32 v20, v20, v20
    v_and_b32 v20, s50, v20
    v_mul_f32 v20, s51, v20
    v_cvt_pk_bf16_f32 v20, v20, v20
    v_and_b32 v20, s50, v20
    s_nop 1
    v_max_f32_dpp v21, v20, v20 row_ror:4 row_mask:0xf bank_mask:0xf
    s_nop 1
    v_max_f32_dpp v21, v21, v21 row_ror:8 row_mask:0xf bank_mask:0xf
    v_max_f32 v21, v21, v5
    v_sub_f32 v22, v5, v21
    v_sub_f32 v20, v20, v21
    v_mov_b32 v5, v21
    v_mul_f32 v22, s52, v22
    v_mul_f32 v20, s52, v20
    v_exp_f32 v26, v22
    v_exp_f32 v20, v20
    v_pk_mul_f32 v[8:9], v[8:9], v[26:27] op_sel_hi:[1,0]
    v_pk_mul_f32 v[10:11], v[10:11], v[26:27] op_sel_hi:[1,0]
    v_pk_mul_f32 v[12:13], v[12:13], v[26:27] op_sel_hi:[1,0]
    v_pk_mul_f32 v[14:15], v[14:15], v[26:27] op_sel_hi:[1,0]
    v_cvt_pk_bf16_f32 v24, v20, 0
    v_cvt_pk_bf16_f32 v25, 0, v20
    v_fma_f32 v6, v6, v26, v20
    s_waitcnt vmcnt(16)
    v_dot2c_f32_bf16_dpp v8, v24, v88 row_newbcast:0 row_mask:0xf bank_mask:0xf
    v_dot2c_f32_bf16_dpp v9, v25, v88 row_newbcast:0 row_mask:0xf bank_mask:0xf
    v_dot2c_f32_bf16_dpp v10, v24, v89 row_newbcast:0 row_mask:0xf bank_mask:0xf
    v_dot2c_f32_bf16_dpp v11, v25, v89 row_newbcast:0 row_mask:0xf bank_mask:0xf
    v_dot2c_f32_bf16_dpp v12, v24, v90 row_newbcast:0 row_mask:0xf bank_mask:0xf
    v_dot2c_f32_bf16_dpp v13, v25, v90 row_newbcast:0 row_mask:0xf bank_mask:0xf
    v_dot2c_f32_bf16_dpp v14, v24, v91 row_newbcast:0 row_mask:0xf bank_mask:0xf
    v_dot2c_f32_bf16_dpp v15, v25, v91 row_newbcast:0 row_mask:0xf bank_mask:0xf
    v_dot2c_f32_bf16_dpp v8, v24, v92 row_newbcast:8 row_mask:0xf bank_mask:0xf
    v_dot2c_f32_bf16_dpp v9, v25, v92 row_newbcast:8 row_mask:0xf bank_mask:0xf
    v_dot2c_f32_bf16_dpp v10, v24, v93 row_newbcast:8 row_mask:0xf bank_mask:0xf
    v_dot2c_f32_bf16_dpp v11, v25, v93 row_newbcast:8 row_mask:0xf bank_mask:0xf
    v_dot2c_f32_bf16_dpp v12, v24, v94 row_newbcast:8 row_mask:0xf bank_mask:0xf
    v_dot2c_f32_bf16_dpp v13, v25, v94 row_newbcast:8 row_mask:0xf bank_mask:0xf
    v_dot2c_f32_bf16_dpp v14, v24, v95 row_newbcast:8 row_mask:0xf bank_mask:0xf
    v_dot2c_f32_bf16_dpp v15, v25, v95 row_newbcast:8 row_mask:0xf bank_mask:0xf
    v_dot2c_f32_bf16_dpp v8, v24, v96 row_newbcast:4 row_mask:0xf bank_mask:0xf
    v_dot2c_f32_bf16_dpp v9, v25, v96 row_newbcast:4 row_mask:0xf bank_mask:0xf
    v_dot2c_f32_bf16_dpp v10, v24, v97 row_newbcast:4 row_mask:0xf bank_mask:0xf
    v_dot2c_f32_bf16_dpp v11, v25, v97 row_newbcast:4 row_mask:0xf bank_mask:0xf
    v_dot2c_f32_bf16_dpp v12, v24, v98 row_newbcast:4 row_mask:0xf bank_mask:0xf
    v_dot2c_f32_bf16_dpp v13, v25, v98 row_newbcast:4 row_mask:0xf bank_mask:0xf
    v_dot2c_f32_bf16_dpp v14, v24, v99 row_newbcast:4 row_mask:0xf bank_mask:0xf
    v_dot2c_f32_bf16_dpp v15, v25, v99 row_newbcast:4 row_mask:0xf bank_mask:0xf
    v_dot2c_f32_bf16_dpp v8, v24, v100 row_newbcast:12 row_mask:0xf bank_mask:0xf
    v_dot2c_f32_bf16_dpp v9, v25, v100 row_newbcast:12 row_mask:0xf bank_mask:0xf
    v_dot2c_f32_bf16_dpp v10, v24, v101 row_newbcast:12 row_mask:0xf bank_mask:0xf
    v_dot2c_f32_bf16_dpp v11, v25, v101 row_newbcast:12 row_mask:0xf bank_mask:0xf
    v_dot2c_f32_bf16_dpp v12, v24, v102 row_newbcast:12 row_mask:0xf bank_mask:0xf
    v_dot2c_f32_bf16_dpp v13, v25, v102 row_newbcast:12 row_mask:0xf bank_mask:0xf
    v_dot2c_f32_bf16_dpp v14, v24, v103 row_newbcast:12 row_mask:0xf bank_mask:0xf
    v_dot2c_f32_bf16_dpp v15, v25, v103 row_newbcast:12 row_mask:0xf bank_mask:0xf
    v_add_u32 v7, s49, v1
    ds_read_b128 v[40:43], v7 offset:0
    ds_read_b128 v[44:47], v7 offset:8192
    ds_read_b128 v[48:51], v7 offset:16384
    ds_read_b128 v[52:55], v7 offset:24576
    ds_read_b128 v[56:59], v7 offset:32768
    ds_read_b128 v[60:63], v7 offset:40960
    ds_read_b128 v[64:67], v7 offset:49152
    ds_read_b128 v[68:71], v7 offset:57344
    v_add_u32 v7, 0x10000, v7
    ds_read_b128 v[72:75], v7 offset:0
    ds_read_b128 v[76:79], v7 offset:8192
    ds_read_b128 v[80:83], v7 offset:16384
    ds_read_b128 v[84:87], v7 offset:24576
    s_waitcnt vmcnt(12)
    v_dot2_f32_bf16 v20, v192, v16, 0
    v_dot2_f32_bf16 v21, v196, v16, 0
    v_dot2_f32_bf16 v22, v200, v16, 0
    v_dot2_f32_bf16 v23, v204, v16, 0
    v_dot2c_f32_bf16 v20, v193, v17
    v_dot2c_f32_bf16 v21, v197, v17
    v_dot2c_f32_bf16 v22, v201, v17
    v_dot2c_f32_bf16 v23, v205, v17
    v_dot2c_f32_bf16 v20, v194, v18
    v_dot2c_f32_bf16 v21, v198, v18
    v_dot2c_f32_bf16 v22, v202, v18
    v_dot2c_f32_bf16 v23, v206, v18
    v_dot2c_f32_bf16 v20, v195, v19
    v_dot2c_f32_bf16 v21, v199, v19
    v_dot2c_f32_bf16 v22, v203, v19
    v_dot2c_f32_bf16 v23, v207, v19
    v_add_f32_dpp v20, v20, v20 row_ror:8 row_mask:0xf bank_mask:0x3
    s_nop 0
    v_add_f32_dpp v22, v22, v22 row_ror:8 row_mask:0xf bank_mask:0x3
    v_add_f32_dpp v20, v21, v21 row_ror:8 row_mask:0xf bank_mask:0xc
    s_nop 0
    v_add_f32_dpp v22, v23, v23 row_ror:8 row_mask:0xf bank_mask:0xc
    v_add_f32_dpp v20, v20, v20 row_half_mirror row_mask:0xf bank_mask:0x5
    s_nop 1
    v_add_f32_dpp v20, v22, v22 row_half_mirror row_mask:0xf bank_mask:0xa
    s_nop 1
    v_add_f32_dpp v20, v20, v20 quad_perm:[1,0,3,2] row_mask:0xf bank_mask:0xf
    s_nop 1
    v_add_f32_dpp v20, v20, v20 quad_perm:[2,3,0,1] row_mask:0xf bank_mask:0xf
    v_cvt_pk_bf16_f32 v20, v20, v20
    v_and_b32 v20, s50, v20
    v_mul_f32 v20, s51, v20
    v_cvt_pk_bf16_f32 v20, v20, v20
    v_and_b32 v20, s50, v20
    s_nop 1
    v_max_f32_dpp v21, v20, v20 row_ror:4 row_mask:0xf bank_mask:0xf
    s_nop 1
    v_max_f32_dpp v21, v21, v21 row_ror:8 row_mask:0xf bank_mask:0xf
    v_max_f32 v21, v21, v5
    v_sub_f32 v22, v5, v21
    v_sub_f32 v20, v20, v21
    v_mov_b32 v5, v21
    v_mul_f32 v22, s52, v22
    v_mul_f32 v20, s52, v20
    v_exp_f32 v26, v22
    v_exp_f32 v20, v20
    v_pk_mul_f32 v[8:9], v[8:9], v[26:27] op_sel_hi:[1,0]
    v_pk_mul_f32 v[10:11], v[10:11], v[26:27] op_sel_hi:[1,0]
    v_pk_mul_f32 v[12:13], v[12:13], v[26:27] op_sel_hi:[1,0]
    v_pk_mul_f32 v[14:15], v[14:15], v[26:27] op_sel_hi:[1,0]
    v_cvt_pk_bf16_f32 v24, v20, 0
    v_cvt_pk_bf16_f32 v25, 0, v20
    v_fma_f32 v6, v6, v26, v20
    s_waitcnt vmcnt(8)
    v_dot2c_f32_bf16_dpp v8, v24, v208 row_newbcast:0 row_mask:0xf bank_mask:0xf
    v_dot2c_f32_bf16_dpp v9, v25, v208 row_newbcast:0 row_mask:0xf bank_mask:0xf
    v_dot2c_f32_bf16_dpp v10, v24, v209 row_newbcast:0 row_mask:0xf bank_mask:0xf
    v_dot2c_f32_bf16_dpp v11, v25, v209 row_newbcast:0 row_mask:0xf bank_mask:0xf
    v_dot2c_f32_bf16_dpp v12, v24, v210 row_newbcast:0 row_mask:0xf bank_mask:0xf
    v_dot2c_f32_bf16_dpp v13, v25, v210 row_newbcast:0 row_mask:0xf bank_mask:0xf
    v_dot2c_f32_bf16_dpp v14, v24, v211 row_newbcast:0 row_mask:0xf bank_mask:0xf
    v_dot2c_f32_bf16_dpp v15, v25, v211 row_newbcast:0 row_mask:0xf bank_mask:0xf
    v_dot2c_f32_bf16_dpp v8, v24, v212 row_newbcast:8 row_mask:0xf bank_mask:0xf
    v_dot2c_f32_bf16_dpp v9, v25, v212 row_newbcast:8 row_mask:0xf bank_mask:0xf
    v_dot2c_f32_bf16_dpp v10, v24, v213 row_newbcast:8 row_mask:0xf bank_mask:0xf
    v_dot2c_f32_bf16_dpp v11, v25, v213 row_newbcast:8 row_mask:0xf bank_mask:0xf
    v_dot2c_f32_bf16_dpp v12, v24, v214 row_newbcast:8 row_mask:0xf bank_mask:0xf
    v_dot2c_f32_bf16_dpp v13, v25, v214 row_newbcast:8 row_mask:0xf bank_mask:0xf
    v_dot2c_f32_bf16_dpp v14, v24, v215 row_newbcast:8 row_mask:0xf bank_mask:0xf
    v_dot2c_f32_bf16_dpp v15, v25, v215 row_newbcast:8 row_mask:0xf bank_mask:0xf
    v_dot2c_f32_bf16_dpp v8, v24, v216 row_newbcast:4 row_mask:0xf bank_mask:0xf
    v_dot2c_f32_bf16_dpp v9, v25, v216 row_newbcast:4 row_mask:0xf bank_mask:0xf
    v_dot2c_f32_bf16_dpp v10, v24, v217 row_newbcast:4 row_mask:0xf bank_mask:0xf
    v_dot2c_f32_bf16_dpp v11, v25, v217 row_newbcast:4 row_mask:0xf bank_mask:0xf
    v_dot2c_f32_bf16_dpp v12, v24, v218 row_newbcast:4 row_mask:0xf bank_mask:0xf
    v_dot2c_f32_bf16_dpp v13, v25, v218 row_newbcast:4 row_mask:0xf bank_mask:0xf
    v_dot2c_f32_bf16_dpp v14, v24, v219 row_newbcast:4 row_mask:0xf bank_mask:0xf
    v_dot2c_f32_bf16_dpp v15, v25, v219 row_newbcast:4 row_mask:0xf bank_mask:0xf
    v_dot2c_f32_bf16_dpp v8, v24, v220 row_newbcast:12 row_mask:0xf bank_mask:0xf
    v_dot2c_f32_bf16_dpp v9, v25, v220 row_newbcast:12 row_mask:0xf bank_mask:0xf
    v_dot2c_f32_bf16_dpp v10, v24, v221 row_newbcast:12 row_mask:0xf bank_mask:0xf
    v_dot2c_f32_bf16_dpp v11, v25, v221 row_newbcast:12 row_mask:0xf bank_mask:0xf
    v_dot2c_f32_bf16_dpp v12, v24, v222 row_newbcast:12 row_mask:0xf bank_mask:0xf
    v_dot2c_f32_bf16_dpp v13, v25, v222 row_newbcast:12 row_mask:0xf bank_mask:0xf
    v_dot2c_f32_bf16_dpp v14, v24, v223 row_newbcast:12 row_mask:0xf bank_mask:0xf
    v_dot2c_f32_bf16_dpp v15, v25, v223 row_newbcast:12 row_mask:0xf bank_mask:0xf
    s_waitcnt lgkmcnt(0)
    v_perm_b32 v88, v44, v40, s53
    v_perm_b32 v44, v44, v40, s54
    v_perm_b32 v40, v45, v41, s53
    v_perm_b32 v45, v45, v41, s54
    v_perm_b32 v41, v46, v42, s53
    v_perm_b32 v46, v46, v42, s54
    v_perm_b32 v42, v47, v43, s53
    v_perm_b32 v47, v47, v43, s54
    v_perm_b32 v43, v52, v48, s53
    v_perm_b32 v52, v52, v48, s54
    v_perm_b32 v48, v53, v49, s53
    v_perm_b32 v53, v53, v49, s54
    v_perm_b32 v49, v54, v50, s53
    v_perm_b32 v54, v54, v50, s54
    v_perm_b32 v50, v55, v51, s53
    v_perm_b32 v55, v55, v51, s54
    v_perm_b32 v51, v60, v56, s53
    v_perm_b32 v60, v60, v56, s54
    v_perm_b32 v56, v61, v57, s53
    v_perm_b32 v61, v61, v57, s54
    v_perm_b32 v57, v62, v58, s53
    v_perm_b32 v62, v62, v58, s54
    v_perm_b32 v58, v63, v59, s53
    v_perm_b32 v63, v63, v59, s54
    v_perm_b32 v59, v68, v64, s53
    v_perm_b32 v68, v68, v64, s54
    v_perm_b32 v64, v69, v65, s53
    v_perm_b32 v69, v69, v65, s54
    v_perm_b32 v65, v70, v66, s53
    v_perm_b32 v70, v70, v66, s54
    v_perm_b32 v66, v71, v67, s53
    v_perm_b32 v71, v71, v67, s54
    v_perm_b32 v67, v76, v72, s53
    v_perm_b32 v76, v76, v72, s54
    v_perm_b32 v72, v77, v73, s53
    v_perm_b32 v77, v77, v73, s54
    v_perm_b32 v73, v78, v74, s53
    v_perm_b32 v78, v78, v74, s54
    v_perm_b32 v74, v79, v75, s53
    v_perm_b32 v79, v79, v75, s54
    v_perm_b32 v75, v84, v80, s53
    v_perm_b32 v84, v84, v80, s54
    v_perm_b32 v80, v85, v81, s53
    v_perm_b32 v85, v85, v81, s54
    v_perm_b32 v81, v86, v82, s53
    v_perm_b32 v86, v86, v82, s54
    v_perm_b32 v82, v87, v83, s53
    v_perm_b32 v87, v87, v83, s54
    v_mov_b32 v83, v88
    s_waitcnt vmcnt(4)
    v_dot2_f32_bf16 v20, v224, v16, 0
    v_dot2_f32_bf16 v21, v228, v16, 0
    v_dot2_f32_bf16 v22, v232, v16, 0
    v_dot2_f32_bf16 v23, v236, v16, 0
    v_dot2c_f32_bf16 v20, v225, v17
    v_dot2c_f32_bf16 v21, v229, v17
    v_dot2c_f32_bf16 v22, v233, v17
    v_dot2c_f32_bf16 v23, v237, v17
    v_dot2c_f32_bf16 v20, v226, v18
    v_dot2c_f32_bf16 v21, v230, v18
    v_dot2c_f32_bf16 v22, v234, v18
    v_dot2c_f32_bf16 v23, v238, v18
    v_dot2c_f32_bf16 v20, v227, v19
    v_dot2c_f32_bf16 v21, v231, v19
    v_dot2c_f32_bf16 v22, v235, v19
    v_dot2c_f32_bf16 v23, v239, v19
    v_add_f32_dpp v20, v20, v20 row_ror:8 row_mask:0xf bank_mask:0x3
    s_nop 0
    v_add_f32_dpp v22, v22, v22 row_ror:8 row_mask:0xf bank_mask:0x3
    v_add_f32_dpp v20, v21, v21 row_ror:8 row_mask:0xf bank_mask:0xc
    s_nop 0
    v_add_f32_dpp v22, v23, v23 row_ror:8 row_mask:0xf bank_mask:0xc
    v_add_f32_dpp v20, v20, v20 row_half_mirror row_mask:0xf bank_mask:0x5
    s_nop 1
    v_add_f32_dpp v20, v22, v22 row_half_mirror row_mask:0xf bank_mask:0xa
    s_nop 1
    v_add_f32_dpp v20, v20, v20 quad_perm:[1,0,3,2] row_mask:0xf bank_mask:0xf
    s_nop 1
    v_add_f32_dpp v20, v20, v20 quad_perm:[2,3,0,1] row_mask:0xf bank_mask:0xf
    v_cvt_pk_bf16_f32 v20, v20, v20
    v_and_b32 v20, s50, v20
    v_mul_f32 v20, s51, v20
    v_cvt_pk_bf16_f32 v20, v20, v20
    v_and_b32 v20, s50, v20
    s_nop 1
    v_max_f32_dpp v21, v20, v20 row_ror:4 row_mask:0xf bank_mask:0xf
    s_nop 1
    v_max_f32_dpp v21, v21, v21 row_ror:8 row_mask:0xf bank_mask:0xf
    v_max_f32 v21, v21, v5
    v_sub_f32 v22, v5, v21
    v_sub_f32 v20, v20, v21
    v_mov_b32 v5, v21
    v_mul_f32 v22, s52, v22
    v_mul_f32 v20, s52, v20
    v_exp_f32 v26, v22
    v_exp_f32 v20, v20
    v_pk_mul_f32 v[8:9], v[8:9], v[26:27] op_sel_hi:[1,0]
    v_pk_mul_f32 v[10:11], v[10:11], v[26:27] op_sel_hi:[1,0]
    v_pk_mul_f32 v[12:13], v[12:13], v[26:27] op_sel_hi:[1,0]
    v_pk_mul_f32 v[14:15], v[14:15], v[26:27] op_sel_hi:[1,0]
    v_cvt_pk_bf16_f32 v24, v20, 0
    v_cvt_pk_bf16_f32 v25, 0, v20
    v_fma_f32 v6, v6, v26, v20
    s_waitcnt vmcnt(0)
    v_dot2c_f32_bf16_dpp v8, v24, v240 row_newbcast:0 row_mask:0xf bank_mask:0xf
    v_dot2c_f32_bf16_dpp v9, v25, v240 row_newbcast:0 row_mask:0xf bank_mask:0xf
    v_dot2c_f32_bf16_dpp v10, v24, v241 row_newbcast:0 row_mask:0xf bank_mask:0xf
    v_dot2c_f32_bf16_dpp v11, v25, v241 row_newbcast:0 row_mask:0xf bank_mask:0xf
    v_dot2c_f32_bf16_dpp v12, v24, v242 row_newbcast:0 row_mask:0xf bank_mask:0xf
    v_dot2c_f32_bf16_dpp v13, v25, v242 row_newbcast:0 row_mask:0xf bank_mask:0xf
    v_dot2c_f32_bf16_dpp v14, v24, v243 row_newbcast:0 row_mask:0xf bank_mask:0xf
    v_dot2c_f32_bf16_dpp v15, v25, v243 row_newbcast:0 row_mask:0xf bank_mask:0xf
    v_dot2c_f32_bf16_dpp v8, v24, v244 row_newbcast:8 row_mask:0xf bank_mask:0xf
    v_dot2c_f32_bf16_dpp v9, v25, v244 row_newbcast:8 row_mask:0xf bank_mask:0xf
    v_dot2c_f32_bf16_dpp v10, v24, v245 row_newbcast:8 row_mask:0xf bank_mask:0xf
    v_dot2c_f32_bf16_dpp v11, v25, v245 row_newbcast:8 row_mask:0xf bank_mask:0xf
    v_dot2c_f32_bf16_dpp v12, v24, v246 row_newbcast:8 row_mask:0xf bank_mask:0xf
    v_dot2c_f32_bf16_dpp v13, v25, v246 row_newbcast:8 row_mask:0xf bank_mask:0xf
    v_dot2c_f32_bf16_dpp v14, v24, v247 row_newbcast:8 row_mask:0xf bank_mask:0xf
    v_dot2c_f32_bf16_dpp v15, v25, v247 row_newbcast:8 row_mask:0xf bank_mask:0xf
    v_dot2c_f32_bf16_dpp v8, v24, v248 row_newbcast:4 row_mask:0xf bank_mask:0xf
    v_dot2c_f32_bf16_dpp v9, v25, v248 row_newbcast:4 row_mask:0xf bank_mask:0xf
    v_dot2c_f32_bf16_dpp v10, v24, v249 row_newbcast:4 row_mask:0xf bank_mask:0xf
    v_dot2c_f32_bf16_dpp v11, v25, v249 row_newbcast:4 row_mask:0xf bank_mask:0xf
    v_dot2c_f32_bf16_dpp v12, v24, v250 row_newbcast:4 row_mask:0xf bank_mask:0xf
    v_dot2c_f32_bf16_dpp v13, v25, v250 row_newbcast:4 row_mask:0xf bank_mask:0xf
    v_dot2c_f32_bf16_dpp v14, v24, v251 row_newbcast:4 row_mask:0xf bank_mask:0xf
    v_dot2c_f32_bf16_dpp v15, v25, v251 row_newbcast:4 row_mask:0xf bank_mask:0xf
    v_dot2c_f32_bf16_dpp v8, v24, v252 row_newbcast:12 row_mask:0xf bank_mask:0xf
    v_dot2c_f32_bf16_dpp v9, v25, v252 row_newbcast:12 row_mask:0xf bank_mask:0xf
    v_dot2c_f32_bf16_dpp v10, v24, v253 row_newbcast:12 row_mask:0xf bank_mask:0xf
    v_dot2c_f32_bf16_dpp v11, v25, v253 row_newbcast:12 row_mask:0xf bank_mask:0xf
    v_dot2c_f32_bf16_dpp v12, v24, v254 row_newbcast:12 row_mask:0xf bank_mask:0xf
    v_dot2c_f32_bf16_dpp v13, v25, v254 row_newbcast:12 row_mask:0xf bank_mask:0xf
    v_dot2c_f32_bf16_dpp v14, v24, v255 row_newbcast:12 row_mask:0xf bank_mask:0xf
    v_dot2c_f32_bf16_dpp v15, v25, v255 row_newbcast:12 row_mask:0xf bank_mask:0xf
    s_setprio 1
    v_add_f32_dpp v6, v6, v6 row_ror:4 row_mask:0xf bank_mask:0xf
    v_mov_b32 v20, v5
    v_mov_b32 v21, v5
    v_add_f32_dpp v6, v6, v6 row_ror:8 row_mask:0xf bank_mask:0xf
    s_nop 0
    v_permlane32_swap_b32 v20, v21
    v_max_f32 v20, v20, v21
    v_mov_b32 v21, v20
    s_nop 1
    v_permlane16_swap_b32 v20, v21
    v_max_f32 v20, v20, v21
    v_sub_f32 v22, v5, v20
    v_mul_f32 v22, s52, v22
    v_exp_f32 v26, v22
    s_nop 0
    v_pk_mul_f32 v[8:9], v[8:9], v[26:27] op_sel_hi:[1,0]
    v_pk_mul_f32 v[10:11], v[10:11], v[26:27] op_sel_hi:[1,0]
    v_pk_mul_f32 v[12:13], v[12:13], v[26:27] op_sel_hi:[1,0]
    v_pk_mul_f32 v[14:15], v[14:15], v[26:27] op_sel_hi:[1,0]
    v_mul_f32 v21, v6, v26
    v_mov_b32 v22, v21
    v_permlane32_swap_b32 v8, v12
    v_permlane32_swap_b32 v9, v13
    v_permlane32_swap_b32 v10, v14
    v_permlane32_swap_b32 v11, v15
    v_permlane32_swap_b32 v21, v22
    v_add_f32 v8, v8, v12
    v_add_f32 v9, v9, v13
    v_add_f32 v10, v10, v14
    v_add_f32 v11, v11, v15
    v_add_f32 v21, v21, v22
    v_mov_b32 v22, v21
    v_permlane16_swap_b32 v8, v10
    v_permlane16_swap_b32 v9, v11
    v_permlane16_swap_b32 v21, v22
    v_add_f32 v8, v8, v10
    v_add_f32 v9, v9, v11
    v_add_f32 v21, v21, v22
    ds_write_b64 v4, v[8:9]
    v_mov_b32 v23, s60
    s_mov_b64 exec, 1
    ds_write_b64 v23, v[20:21]
    s_mov_b64 exec, -1
    v_mov_b32 v8, 0
    v_mov_b32 v9, 0
    v_mov_b32 v10, 0
    v_mov_b32 v11, 0
    s_waitcnt lgkmcnt(0)
    s_barrier
    ds_read_b64 v[20:21], v31
    ds_read_b64 v[88:89], v33 offset:0
    ds_read_b64 v[90:91], v33 offset:512
    ds_read_b64 v[92:93], v33 offset:1024
    ds_read_b64 v[94:95], v33 offset:1536
    ds_read_b64 v[96:97], v33 offset:2048
    ds_read_b64 v[98:99], v33 offset:2560
    ds_read_b64 v[100:101], v33 offset:3072
    ds_read_b64 v[102:103], v33 offset:3584
    global_load_dwordx4 v[240:243], v[34:35], off
    v_lshl_add_u64 v[34:35], s[38:39], 0, v[34:35]
    s_waitcnt lgkmcnt(8)
    v_max_f32_dpp v22, v20, v20 row_ror:4 row_mask:0xf bank_mask:0xf
    global_load_dwordx4 v[244:247], v[34:35], off
    v_lshl_add_u64 v[34:35], s[38:39], 0, v[34:35]
    v_max_f32_dpp v22, v22, v22 row_ror:2 row_mask:0xf bank_mask:0xf
    s_nop 1
    v_max_f32_dpp v22, v22, v22 row_ror:1 row_mask:0xf bank_mask:0xf
    v_sub_f32 v20, v20, v22
    v_mul_f32 v20, s52, v20
    v_exp_f32 v20, v20
    s_nop 0
    v_mul_f32 v21, v21, v20
    s_waitcnt lgkmcnt(0)
    s_nop 0
    v_add_f32_dpp v21, v21, v21 row_ror:4 row_mask:0xf bank_mask:0xf
    v_fmac_f32_dpp v8, v20, v88 row_newbcast:0 row_mask:0xf bank_mask:0xf
    v_fmac_f32_dpp v9, v20, v89 row_newbcast:0 row_mask:0xf bank_mask:0xf
    v_add_f32_dpp v21, v21, v21 row_ror:2 row_mask:0xf bank_mask:0xf
    v_fmac_f32_dpp v10, v20, v90 row_newbcast:1 row_mask:0xf bank_mask:0xf
    v_fmac_f32_dpp v11, v20, v91 row_newbcast:1 row_mask:0xf bank_mask:0xf
    v_add_f32_dpp v21, v21, v21 row_ror:1 row_mask:0xf bank_mask:0xf
    v_fmac_f32_dpp v8, v20, v92 row_newbcast:2 row_mask:0xf bank_mask:0xf
    v_fmac_f32_dpp v9, v20, v93 row_newbcast:2 row_mask:0xf bank_mask:0xf
    v_rcp_f32 v21, v21
    v_fmac_f32_dpp v10, v20, v94 row_newbcast:3 row_mask:0xf bank_mask:0xf
    v_fmac_f32_dpp v11, v20, v95 row_newbcast:3 row_mask:0xf bank_mask:0xf
    global_load_dwordx4 v[248:251], v[34:35], off
    v_lshl_add_u64 v[34:35], s[38:39], 0, v[34:35]
    v_fmac_f32_dpp v8, v20, v96 row_newbcast:4 row_mask:0xf bank_mask:0xf
    v_fmac_f32_dpp v9, v20, v97 row_newbcast:4 row_mask:0xf bank_mask:0xf
    v_fmac_f32_dpp v10, v20, v98 row_newbcast:5 row_mask:0xf bank_mask:0xf
    v_fmac_f32_dpp v11, v20, v99 row_newbcast:5 row_mask:0xf bank_mask:0xf
    v_fmac_f32_dpp v8, v20, v100 row_newbcast:6 row_mask:0xf bank_mask:0xf
    v_fmac_f32_dpp v9, v20, v101 row_newbcast:6 row_mask:0xf bank_mask:0xf
    global_load_dwordx4 v[252:255], v[34:35], off
    v_fmac_f32_dpp v10, v20, v102 row_newbcast:7 row_mask:0xf bank_mask:0xf
    v_fmac_f32_dpp v11, v20, v103 row_newbcast:7 row_mask:0xf bank_mask:0xf
    v_pk_add_f32 v[8:9], v[8:9], v[10:11]
    v_mul_f32 v8, v8, v21
    v_mul_f32 v9, v9, v21
    v_cvt_pk_bf16_f32 v22, v8, v9
    ds_write_b16 v36, v22
    ds_write_b16_d16_hi v37, v22
    ds_read_b128 v[88:91], v39 offset:0
    ds_read_b128 v[92:95], v39 offset:16
    ds_read_b128 v[96:99], v39 offset:32
    s_mov_b32 s46, 0
    buffer_load_dwordx4 v[192:195], v32, s[24:27], s46 offen
    s_mov_b32 s46, 7680
    buffer_load_dwordx4 v[196:199], v32, s[24:27], s46 offen
    s_waitcnt lgkmcnt(2)
    v_dot2_f32_bf16 v8, v88, v187, 0
    v_dot2_f32_bf16 v9, v88, v108, 0
    v_dot2_f32_bf16 v10, v88, v104, 0
    v_dot2_f32_bf16 v11, v88, v109, 0
    v_dot2_f32_bf16 v12, v88, v105, 0
    v_dot2_f32_bf16 v13, v88, v110, 0
    v_dot2_f32_bf16 v14, v88, v106, 0
    v_dot2_f32_bf16 v15, v88, v111, 0
    s_mov_b32 s46, 15360
    buffer_load_dwordx4 v[200:203], v32, s[24:27], s46 offen
    v_dot2c_f32_bf16 v8, v89, v107
    v_dot2c_f32_bf16 v9, v89, v116
    v_dot2c_f32_bf16 v10, v89, v112
    v_dot2c_f32_bf16 v11, v89, v117
    v_dot2c_f32_bf16 v12, v89, v113
    v_dot2c_f32_bf16 v13, v89, v118
    v_dot2c_f32_bf16 v14, v89, v114
    v_dot2c_f32_bf16 v15, v89, v119
    s_mov_b32 s46, 23040
    buffer_load_dwordx4 v[204:207], v32, s[24:27], s46 offen
    v_dot2c_f32_bf16 v8, v90, v115
    v_dot2c_f32_bf16 v9, v90, v124
    v_dot2c_f32_bf16 v10, v90, v120
    v_dot2c_f32_bf16 v11, v90, v125
    v_dot2c_f32_bf16 v12, v90, v121
    v_dot2c_f32_bf16 v13, v90, v126
    v_dot2c_f32_bf16 v14, v90, v122
    v_dot2c_f32_bf16 v15, v90, v127
    s_mov_b32 s46, 30720
    buffer_load_dwordx4 v[208:211], v32, s[24:27], s46 offen
    v_dot2c_f32_bf16 v8, v91, v123
    v_dot2c_f32_bf16 v9, v91, v132
    v_dot2c_f32_bf16 v10, v91, v128
    v_dot2c_f32_bf16 v11, v91, v133
    v_dot2c_f32_bf16 v12, v91, v129
    v_dot2c_f32_bf16 v13, v91, v134
    v_dot2c_f32_bf16 v14, v91, v130
    v_dot2c_f32_bf16 v15, v91, v135
    s_mov_b32 s46, 38400
    buffer_load_dwordx4 v[212:215], v32, s[24:27], s46 offen
    s_waitcnt lgkmcnt(1)
    v_dot2c_f32_bf16 v8, v92, v131
    v_dot2c_f32_bf16 v9, v92, v140
    v_dot2c_f32_bf16 v10, v92, v136
    v_dot2c_f32_bf16 v11, v92, v141
    v_dot2c_f32_bf16 v12, v92, v137
    v_dot2c_f32_bf16 v13, v92, v142
    v_dot2c_f32_bf16 v14, v92, v138
    v_dot2c_f32_bf16 v15, v92, v143
    s_mov_b32 s46, 46080
    buffer_load_dwordx4 v[216:219], v32, s[24:27], s46 offen
    v_dot2c_f32_bf16 v8, v93, v139
    v_dot2c_f32_bf16 v9, v93, v148
    v_dot2c_f32_bf16 v10, v93, v144
    v_dot2c_f32_bf16 v11, v93, v149
    v_dot2c_f32_bf16 v12, v93, v145
    v_dot2c_f32_bf16 v13, v93, v150
    v_dot2c_f32_bf16 v14, v93, v146
    v_dot2c_f32_bf16 v15, v93, v151
    s_mov_b32 s46, 53760
    buffer_load_dwordx4 v[220:223], v32, s[24:27], s46 offen
    v_dot2c_f32_bf16 v8, v94, v147
    v_dot2c_f32_bf16 v9, v94, v156
    v_dot2c_f32_bf16 v10, v94, v152
    v_dot2c_f32_bf16 v11, v94, v157
    v_dot2c_f32_bf16 v12, v94, v153
    v_dot2c_f32_bf16 v13, v94, v158
    v_dot2c_f32_bf16 v14, v94, v154
    v_dot2c_f32_bf16 v15, v94, v159
    s_mov_b32 s46, 61440
    buffer_load_dwordx4 v[224:227], v32, s[24:27], s46 offen
    v_dot2c_f32_bf16 v8, v95, v155
    v_dot2c_f32_bf16 v9, v95, v164
    v_dot2c_f32_bf16 v10, v95, v160
    v_dot2c_f32_bf16 v11, v95, v165
    v_dot2c_f32_bf16 v12, v95, v161
    v_dot2c_f32_bf16 v13, v95, v166
    v_dot2c_f32_bf16 v14, v95, v162
    v_dot2c_f32_bf16 v15, v95, v167
    s_mov_b32 s46, 69120
    buffer_load_dwordx4 v[228:231], v32, s[24:27], s46 offen
    s_waitcnt lgkmcnt(0)
    v_dot2c_f32_bf16 v8, v96, v163
    v_dot2c_f32_bf16 v9, v96, v172
    v_dot2c_f32_bf16 v10, v96, v168
    v_dot2c_f32_bf16 v11, v96, v173
    v_dot2c_f32_bf16 v12, v96, v169
    v_dot2c_f32_bf16 v13, v96, v174
    v_dot2c_f32_bf16 v14, v96, v170
    v_dot2c_f32_bf16 v15, v96, v175
    v_add_u32 v7, 76800, v32
    buffer_load_dwordx4 v[232:235], v7, s[24:27], 0 offen
    v_dot2c_f32_bf16 v8, v97, v171
    v_dot2c_f32_bf16 v9, v97, v180
    v_dot2c_f32_bf16 v10, v97, v176
    v_dot2c_f32_bf16 v11, v97, v181
    v_dot2c_f32_bf16 v12, v97, v177
    v_dot2c_f32_bf16 v13, v97, v182
    v_dot2c_f32_bf16 v14, v97, v178
    v_dot2c_f32_bf16 v15, v97, v183
    v_dot2c_f32_bf16 v8, v98, v179
    v_dot2c_f32_bf16 v9, v98, v188
    v_dot2c_f32_bf16 v10, v98, v184
    v_dot2c_f32_bf16 v11, v98, v189
    v_dot2c_f32_bf16 v12, v98, v185
    v_dot2c_f32_bf16 v13, v98, v190
    v_dot2c_f32_bf16 v14, v98, v186
    v_dot2c_f32_bf16 v15, v98, v191
    ds_write_b128 v28, v[8:11]
    s_nop 1
    ds_write_b128 v28, v[12:15] offset:8320
    s_waitcnt lgkmcnt(0)
    s_barrier
    ds_read_b32 v88, v29 offset:0
    ds_read_b32 v89, v29 offset:1280
    ds_read_b32 v90, v29 offset:2560
    ds_read_b32 v91, v29 offset:3840
    ds_read_b32 v92, v29 offset:5120
    ds_read_b32 v93, v29 offset:6400
    s_cmp_ge_u32 s40, 3
    s_cbranch_scc1 L_one
    ds_read_b32 v94, v29 offset:960
    ds_read_b32 v95, v29 offset:2240
    ds_read_b32 v96, v29 offset:3520
    ds_read_b32 v97, v29 offset:4800
    ds_read_b32 v98, v29 offset:6080
    ds_read_b32 v99, v29 offset:7360
    v_cmp_gt_u32 vcc, 176, v0
    s_waitcnt lgkmcnt(6)
    v_add_f32 v88, v88, v89
    v_add_f32 v90, v90, v91
    v_add_f32 v92, v92, v93
    v_add_f32 v88, v88, v90
    v_add_f32 v88, v88, v92
    v_cndmask_b32 v88, v88, 1.0, s[64:65]
    global_atomic_add_f32 v30, v88, s[68:69] offset:0
    s_mov_b64 exec, vcc
    s_waitcnt lgkmcnt(0)
    v_add_f32 v94, v94, v95
    v_add_f32 v96, v96, v97
    v_add_f32 v98, v98, v99
    v_add_f32 v94, v94, v96
    v_add_f32 v94, v94, v98
    v_cndmask_b32 v94, 0, v94, s[66:67]
    v_cndmask_b32 v94, v94, 1.0, s[64:65]
    global_atomic_add_f32 v30, v94, s[68:69] offset:2048
    s_mov_b64 exec, -1
    s_branch L_added
L_one:
    s_waitcnt lgkmcnt(0)
    v_add_f32 v88, v88, v89
    v_add_f32 v90, v90, v91
    v_add_f32 v92, v92, v93
    v_add_f32 v88, v88, v90
    v_add_f32 v88, v88, v92
    v_cndmask_b32 v88, v88, 1.0, s[64:65]
    global_atomic_add_f32 v30, v88, s[68:69] offset:0
L_added:
    s_cmp_ge_u32 s36, 27
    s_cbranch_scc1 L_done
    v_add_u32 v7, s49, v1
    v_add_u32 v7, 0x10000, v7
    ds_read_b128 v[104:107], v7 offset:32768
    ds_read_b128 v[108:111], v7 offset:40960
    ds_read_b128 v[112:115], v7 offset:49152
    ds_read_b128 v[116:119], v7 offset:57344
    v_and_b32 v170, 63, v0
    v_lshrrev_b32 v171, 4, v170
    v_and_b32 v21, 15, v0
    v_min_u32 v21, 9, v21
    v_lshlrev_b32 v21, 6, v21
    s_lshl_b32 s46, s40, 2
    v_add3_u32 v21, v21, s46, v171
    v_mul_u32_u24 v20, 4370, v21
    v_lshrrev_b32 v20, 16, v20
    v_add_lshl_u32 v172, v20, v21, 2
    v_add_u32 v172, 139392, v172
    v_add_u32 v21, 32, v21
    v_mul_u32_u24 v20, 4370, v21
    v_lshrrev_b32 v20, 16, v20
    v_add_lshl_u32 v173, v20, v21, 2
    v_add_u32 v173, 139392, v173
    v_lshlrev_b32 v174, 2, v170
    v_add_u32 v174, 131136, v174
    v_and_b32 v175, 1, v0
    v_mul_u32_u24 v175, 8320, v175
    v_lshrrev_b32 v21, 1, v0
    v_lshl_add_u32 v175, v21, 4, v175
    v_add_u32 v175, 139392, v175
    v_lshlrev_b32 v30, 2, v30
    v_mov_b32 v176, 142464
    v_and_b32 v22, 7, v0
    v_lshrrev_b32 v177, 3, v170
    v_mul_u32_u24 v177, 2560, v177
    v_lshl_add_u32 v177, v22, 4, v177
    v_cmp_gt_u32 vcc, 24, v170
    v_mov_b32 v178, 0x7fff0000
    v_lshl_add_u32 v21, v22, 2, v171
    v_cndmask_b32 v178, v178, v177, vcc
    s_min_u32 s46, s36, 19
    s_lshl_b32 s46, s46, 5
    v_add_u32 v21, s46, v21
    v_lshlrev_b32 v179, 1, v21
    v_mul_u32_u24 v20, 4370, v21
    v_lshrrev_b32 v20, 16, v20
    v_add_lshl_u32 v180, v20, v21, 2
    v_add_u32 v180, 139392, v180
    s_mul_i32 s46, s37, 2560
    s_add_u32 s46, s46, 0x200000
    s_waitcnt lgkmcnt(0)
    v_perm_b32 v168, v108, v104, s53
    v_perm_b32 v108, v108, v104, s54
    v_perm_b32 v104, v109, v105, s53
    v_perm_b32 v109, v109, v105, s54
    v_perm_b32 v105, v110, v106, s53
    v_perm_b32 v110, v110, v106, s54
    v_perm_b32 v106, v111, v107, s53
    v_perm_b32 v111, v111, v107, s54
    v_perm_b32 v107, v116, v112, s53
    v_perm_b32 v116, v116, v112, s54
    v_perm_b32 v112, v117, v113, s53
    v_perm_b32 v117, v117, v113, s54
    v_perm_b32 v113, v118, v114, s53
    v_perm_b32 v118, v118, v114, s54
    v_perm_b32 v114, v119, v115, s53
    v_perm_b32 v119, v119, v115, s54
    v_mov_b32 v115, v168
    v_mov_b32 v236, 0
    v_mov_b32 v237, 0
    v_mov_b32 v238, 0
    v_mov_b32 v239, 0
    v_mov_b32 v8, 0
    v_mov_b32 v9, 0
    v_mov_b32 v10, 0
    v_mov_b32 v11, 0
    v_mov_b32 v12, 0
    v_mov_b32 v13, 0
    v_mov_b32 v14, 0
    v_mov_b32 v15, 0
    s_waitcnt vmcnt(1)
    v_perm_b32 v168, v244, v240, s53
    v_perm_b32 v244, v244, v240, s54
    v_perm_b32 v240, v245, v241, s53
    v_perm_b32 v245, v245, v241, s54
    v_perm_b32 v241, v246, v242, s53
    v_perm_b32 v246, v246, v242, s54
    v_perm_b32 v242, v247, v243, s53
    v_perm_b32 v247, v247, v243, s54
    v_perm_b32 v243, v252, v248, s53
    v_perm_b32 v252, v252, v248, s54
    v_perm_b32 v248, v253, v249, s53
    v_perm_b32 v253, v253, v249, s54
    v_perm_b32 v249, v254, v250, s53
    v_perm_b32 v254, v254, v250, s54
    v_perm_b32 v250, v255, v251, s53
    v_perm_b32 v255, v255, v251, s54
    v_perm_b32 v251, v196, v192, s53
    v_perm_b32 v196, v196, v192, s54
    v_perm_b32 v192, v197, v193, s53
    v_perm_b32 v197, v197, v193, s54
    v_perm_b32 v193, v198, v194, s53
    v_perm_b32 v198, v198, v194, s54
    v_perm_b32 v194, v199, v195, s53
    v_perm_b32 v199, v199, v195, s54
    v_perm_b32 v195, v204, v200, s53
    v_perm_b32 v204, v204, v200, s54
    v_perm_b32 v200, v205, v201, s53
    v_perm_b32 v205, v205, v201, s54
    v_perm_b32 v201, v206, v202, s53
    v_perm_b32 v206, v206, v202, s54
    v_perm_b32 v202, v207, v203, s53
    v_perm_b32 v207, v207, v203, s54
    v_perm_b32 v203, v212, v208, s53
    v_perm_b32 v212, v212, v208, s54
    v_perm_b32 v208, v213, v209, s53
    v_perm_b32 v213, v213, v209, s54
    v_perm_b32 v209, v214, v210, s53
    v_perm_b32 v214, v214, v210, s54
    v_perm_b32 v210, v215, v211, s53
    v_perm_b32 v215, v215, v211, s54
    v_perm_b32 v211, v220, v216, s53
    v_perm_b32 v220, v220, v216, s54
    v_perm_b32 v216, v221, v217, s53
    v_perm_b32 v221, v221, v217, s54
    v_perm_b32 v217, v222, v218, s53
    v_perm_b32 v222, v222, v218, s54
    v_perm_b32 v218, v223, v219, s53
    v_perm_b32 v223, v223, v219, s54
    v_perm_b32 v219, v228, v224, s53
    v_perm_b32 v228, v228, v224, s54
    v_perm_b32 v224, v229, v225, s53
    v_perm_b32 v229, v229, v225, s54
    v_perm_b32 v225, v230, v226, s53
    v_perm_b32 v230, v230, v226, s54
    v_perm_b32 v226, v231, v227, s53
    v_perm_b32 v231, v231, v227, s54
    v_perm_b32 v227, v236, v232, s53
    v_perm_b32 v236, v236, v232, s54
    v_perm_b32 v232, v237, v233, s53
    v_perm_b32 v237, v237, v233, s54
    v_perm_b32 v233, v238, v234, s53
    v_perm_b32 v238, v238, v234, s54
    v_perm_b32 v234, v239, v235, s53
    v_perm_b32 v239, v239, v235, s54
    v_mov_b32 v235, v168
    s_cmp_lg_u32 s40, 6
    s_cbranch_scc1 L_nopoll2
    s_setprio 3
    v_bfe_u32 v20, v0, 2, 4
    v_mul_u32_u24 v20, 30, v20
    v_and_b32 v21, 3, v0
    v_lshl_add_u32 v20, v21, 3, v20
    v_add_u32 v20, 156032, v20
    ds_read_u16 v120, v20 offset:0
    ds_read_u16 v121, v20 offset:2
    ds_read_u16 v122, v20 offset:4
    ds_read_u16 v123, v20 offset:6
    ds_read_u16 v124, v20 offset:480
    ds_read_u16 v125, v20 offset:482
    ds_read_u16 v126, v20 offset:484
    ds_read_u16 v127, v20 offset:486
    ds_read_u16 v128, v20 offset:960
    ds_read_u16 v129, v20 offset:962
    ds_read_u16 v130, v20 offset:964
    ds_read_u16 v131, v20 offset:966
    s_mov_b32 s70, 0x88888888
    s_mov_b32 s71, 0x88888888
    s_mov_b32 s72, 0x88888888
    s_mov_b32 s73, 0x888
    s_mov_b32 s74, 0x77777777
    s_mov_b32 s75, 0x77777777
    s_mov_b32 s76, 0xffffffff
    s_mov_b32 s77, 0x7ff
    s_mov_b32 s78, 0xffffffff
    s_mov_b32 s79, 0x7ff
    s_mov_b32 s80, 0xffffffff
    s_mov_b32 s81, 0x3ff
    s_mov_b32 s82, 0x77777777
    s_mov_b32 s83, 0x377
    v_add_u32 v148, 139392, v1
    s_waitcnt lgkmcnt(0)
    v_lshlrev_b32 v120, 16, v120
    v_lshlrev_b32 v121, 16, v121
    v_lshlrev_b32 v122, 16, v122
    v_lshlrev_b32 v123, 16, v123
    v_lshlrev_b32 v124, 16, v124
    v_lshlrev_b32 v125, 16, v125
    v_lshlrev_b32 v126, 16, v126
    v_lshlrev_b32 v127, 16, v127
    v_lshlrev_b32 v128, 16, v128
    v_lshlrev_b32 v129, 16, v129
    v_lshlrev_b32 v130, 16, v130
    v_lshlrev_b32 v131, 16, v131
    s_mov_b32 s55, 0x40000
L_poll2:
    buffer_load_dwordx4 v[132:135], v1, s[28:31], s61 offen offset:0 sc1
    buffer_load_dwordx4 v[136:139], v1, s[28:31], s61 offen offset:1024 sc1
    buffer_load_dwordx4 v[140:143], v1, s[28:31], s61 offen offset:2048 sc1
    s_waitcnt vmcnt(0)
    v_min_f32 v20, v135, v139
    v_cmp_neq_f32 vcc, 0x42000000, v143
    s_nop 0
    s_and_b64 s[56:57], vcc, s[72:73]
    v_cmp_neq_f32 vcc, 0x42000000, v20
    s_nop 0
    s_and_b64 vcc, vcc, s[70:71]
    s_or_b64 s[56:57], s[56:57], vcc
    s_cbranch_scc0 L_poll2_ok
    s_sub_u32 s55, s55, 1
    s_cbranch_scc1 L_poll2_ok
    v_cmp_gt_f32 vcc, 0x41f00000, v20
    s_nop 0
    s_and_b64 vcc, vcc, s[70:71]
    s_cbranch_scc0 L_near
    s_sleep 24
L_near:
    s_sleep 1
    s_branch L_poll2
L_poll2_ok:
    v_cvt_pk_bf16_f32 v133, v132, v133
    v_cvt_pk_bf16_f32 v135, v134, v135
    v_cvt_pk_bf16_f32 v137, v136, v137
    v_cvt_pk_bf16_f32 v139, v138, v139
    v_cvt_pk_bf16_f32 v141, v140, v141
    v_cvt_pk_bf16_f32 v143, v142, v143
    v_lshlrev_b32 v132, 16, v133
    v_and_b32 v133, s50, v133
    v_lshlrev_b32 v134, 16, v135
    v_and_b32 v135, s50, v135
    v_lshlrev_b32 v136, 16, v137
    v_and_b32 v137, s50, v137
    v_lshlrev_b32 v138, 16, v139
    v_and_b32 v139, s50, v139
    v_lshlrev_b32 v140, 16, v141
    v_and_b32 v141, s50, v141
    v_lshlrev_b32 v142, 16, v143
    v_and_b32 v143, s50, v143
    v_pk_add_f32 v[132:133], v[132:133], v[120:121]
    v_pk_add_f32 v[134:135], v[134:135], v[122:123]
    v_pk_add_f32 v[136:137], v[136:137], v[124:125]
    v_pk_add_f32 v[138:139], v[138:139], v[126:127]
    v_pk_add_f32 v[140:141], v[140:141], v[128:129]
    v_pk_add_f32 v[142:143], v[142:143], v[130:131]
    v_cvt_pk_bf16_f32 v133, v132, v133
    v_cvt_pk_bf16_f32 v135, v134, v135
    v_cvt_pk_bf16_f32 v137, v136, v137
    v_cvt_pk_bf16_f32 v139, v138, v139
    v_cvt_pk_bf16_f32 v141, v140, v141
    v_cvt_pk_bf16_f32 v143, v142, v143
    v_lshlrev_b32 v132, 16, v133
    v_and_b32 v133, s50, v133
    v_lshlrev_b32 v134, 16, v135
    v_and_b32 v135, s50, v135
    v_lshlrev_b32 v136, 16, v137
    v_and_b32 v137, s50, v137
    v_lshlrev_b32 v138, 16, v139
    v_and_b32 v139, s50, v139
    v_lshlrev_b32 v140, 16, v141
    v_and_b32 v141, s50, v141
    v_lshlrev_b32 v142, 16, v143
    v_and_b32 v143, s50, v143
    ds_write_b128 v148, v[132:135] offset:0
    ds_write_b128 v148, v[136:139] offset:1024
    ds_write_b128 v148, v[140:143] offset:2048
    v_readlane_b32 s59, v132, 0
    v_mov_b32 v146, 0x3acccccd
    s_nop 0
    v_subrev_f32 v132, s59, v132
    v_subrev_f32 v133, s59, v133
    v_subrev_f32 v134, s59, v134
    v_subrev_f32 v135, s59, v135
    v_subrev_f32 v136, s59, v136
    v_subrev_f32 v137, s59, v137
    v_subrev_f32 v138, s59, v138
    v_subrev_f32 v139, s59, v139
    v_subrev_f32 v140, s59, v140
    v_subrev_f32 v141, s59, v141
    v_subrev_f32 v142, s59, v142
    v_subrev_f32 v143, s59, v143
    v_cndmask_b32 v135, 0, v135, s[74:75]
    v_cndmask_b32 v139, 0, v139, s[74:75]
    v_cndmask_b32 v140, 0, v140, s[76:77]
    v_cndmask_b32 v141, 0, v141, s[78:79]
    v_cndmask_b32 v142, 0, v142, s[80:81]
    v_cndmask_b32 v143, 0, v143, s[82:83]
    v_add_f32 v144, v132, v133
    v_mul_f32 v145, v132, v132
    v_fmac_f32 v145, v133, v133
    v_add_f32 v144, v144, v134
    v_fmac_f32 v145, v134, v134
    v_add_f32 v144, v144, v135
    v_fmac_f32 v145, v135, v135
    v_add_f32 v144, v144, v136
    v_fmac_f32 v145, v136, v136
    v_add_f32 v144, v144, v137
    v_fmac_f32 v145, v137, v137
    v_add_f32 v144, v144, v138
    v_fmac_f32 v145, v138, v138
    v_add_f32 v144, v144, v139
    v_fmac_f32 v145, v139, v139
    v_add_f32 v144, v144, v140
    v_fmac_f32 v145, v140, v140
    v_add_f32 v144, v144, v141
    v_fmac_f32 v145, v141, v141
    v_add_f32 v144, v144, v142
    v_fmac_f32 v145, v142, v142
    v_add_f32 v144, v144, v143
    v_fmac_f32 v145, v143, v143
    s_nop 0
    v_add_f32_dpp v144, v144, v144 row_ror:8 row_mask:0xf bank_mask:0xf
    v_add_f32_dpp v145, v145, v145 row_ror:8 row_mask:0xf bank_mask:0xf
    s_nop 0
    v_add_f32_dpp v144, v144, v144 row_ror:4 row_mask:0xf bank_mask:0xf
    v_add_f32_dpp v145, v145, v145 row_ror:4 row_mask:0xf bank_mask:0xf
    s_nop 0
    v_add_f32_dpp v144, v144, v144 row_ror:2 row_mask:0xf bank_mask:0xf
    v_add_f32_dpp v145, v145, v145 row_ror:2 row_mask:0xf bank_mask:0xf
    s_nop 0
    v_add_f32_dpp v144, v144, v144 row_ror:1 row_mask:0xf bank_mask:0xf
    v_add_f32_dpp v145, v145, v145 row_ror:1 row_mask:0xf bank_mask:0xf
    s_nop 1
    v_permlane32_swap_b32 v144, v145
    v_add_f32 v144, v144, v145
    v_mov_b32 v145, v144
    s_nop 1
    v_permlane16_swap_b32 v144, v145
    v_add_f32 v144, v144, v145
    v_mul_f32 v144, v144, v146
    v_mov_b32 v145, v144
    s_nop 1
    v_permlane32_swap_b32 v144, v145
    v_fma_f32 v145, -v144, v144, v145
    v_add_f32 v144, s59, v144
    v_max_f32 v145, 0, v145
    v_cvt_pk_bf16_f32 v144, v144, v144
    v_cvt_pk_bf16_f32 v145, v145, v145
    v_and_b32 v144, s50, v144
    v_and_b32 v145, s50, v145
    v_add_f32 v145, 0x3727c5ac, v145
    v_cvt_pk_bf16_f32 v145, v145, v145
    v_and_b32 v145, s50, v145
    v_sqrt_f32 v145, v145
    s_nop 0
    v_cvt_pk_bf16_f32 v145, v145, v145
    v_and_b32 v145, s50, v145
    v_rcp_f32 v146, v145
    s_mov_b64 exec, 1
    ds_write_b96 v176, v[144:146]
    s_mov_b64 exec, -1
    s_waitcnt lgkmcnt(0)
L_nopoll2:
    s_barrier
    ds_read_b32 v150, v172
    ds_read_b32 v151, v173
    ds_read_b96 v[144:146], v176
    ds_read_b32 v181, v180
    s_waitcnt lgkmcnt(1)
    v_sub_f32 v150, v150, v144
    v_sub_f32 v151, v151, v144
    v_cvt_pk_bf16_f32 v150, v150, v150
    v_cvt_pk_bf16_f32 v151, v151, v151
    v_and_b32 v150, s50, v150
    v_and_b32 v151, s50, v151
    v_mul_f32 v152, v150, v146
    v_mul_f32 v153, v151, v146
    v_fma_f32 v150, -v152, v145, v150
    v_fma_f32 v151, -v153, v145, v151
    v_fma_f32 v150, v150, v146, v152
    v_fma_f32 v151, v151, v146, v153
    v_cvt_pk_bf16_f32 v20, v150, v151
    s_nop 1
    v_dot2c_f32_bf16_dpp v8, v20, v83 row_newbcast:0 row_mask:0xf bank_mask:0xf
    v_dot2c_f32_bf16_dpp v9, v20, v44 row_newbcast:0 row_mask:0xf bank_mask:0xf
    v_dot2c_f32_bf16_dpp v10, v20, v40 row_newbcast:0 row_mask:0xf bank_mask:0xf
    v_dot2c_f32_bf16_dpp v11, v20, v45 row_newbcast:0 row_mask:0xf bank_mask:0xf
    v_dot2c_f32_bf16_dpp v12, v20, v41 row_newbcast:0 row_mask:0xf bank_mask:0xf
    v_dot2c_f32_bf16_dpp v13, v20, v46 row_newbcast:0 row_mask:0xf bank_mask:0xf
    v_dot2c_f32_bf16_dpp v14, v20, v42 row_newbcast:0 row_mask:0xf bank_mask:0xf
    v_dot2c_f32_bf16_dpp v15, v20, v47 row_newbcast:0 row_mask:0xf bank_mask:0xf
    v_dot2c_f32_bf16_dpp v8, v20, v43 row_newbcast:1 row_mask:0xf bank_mask:0xf
    v_dot2c_f32_bf16_dpp v9, v20, v52 row_newbcast:1 row_mask:0xf bank_mask:0xf
    v_dot2c_f32_bf16_dpp v10, v20, v48 row_newbcast:1 row_mask:0xf bank_mask:0xf
    v_dot2c_f32_bf16_dpp v11, v20, v53 row_newbcast:1 row_mask:0xf bank_mask:0xf
    v_dot2c_f32_bf16_dpp v12, v20, v49 row_newbcast:1 row_mask:0xf bank_mask:0xf
    v_dot2c_f32_bf16_dpp v13, v20, v54 row_newbcast:1 row_mask:0xf bank_mask:0xf
    v_dot2c_f32_bf16_dpp v14, v20, v50 row_newbcast:1 row_mask:0xf bank_mask:0xf
    v_dot2c_f32_bf16_dpp v15, v20, v55 row_newbcast:1 row_mask:0xf bank_mask:0xf
    v_dot2c_f32_bf16_dpp v8, v20, v51 row_newbcast:2 row_mask:0xf bank_mask:0xf
    v_dot2c_f32_bf16_dpp v9, v20, v60 row_newbcast:2 row_mask:0xf bank_mask:0xf
    v_dot2c_f32_bf16_dpp v10, v20, v56 row_newbcast:2 row_mask:0xf bank_mask:0xf
    v_dot2c_f32_bf16_dpp v11, v20, v61 row_newbcast:2 row_mask:0xf bank_mask:0xf
    v_dot2c_f32_bf16_dpp v12, v20, v57 row_newbcast:2 row_mask:0xf bank_mask:0xf
    v_dot2c_f32_bf16_dpp v13, v20, v62 row_newbcast:2 row_mask:0xf bank_mask:0xf
    v_dot2c_f32_bf16_dpp v14, v20, v58 row_newbcast:2 row_mask:0xf bank_mask:0xf
    v_dot2c_f32_bf16_dpp v15, v20, v63 row_newbcast:2 row_mask:0xf bank_mask:0xf
    v_dot2c_f32_bf16_dpp v8, v20, v59 row_newbcast:3 row_mask:0xf bank_mask:0xf
    v_dot2c_f32_bf16_dpp v9, v20, v68 row_newbcast:3 row_mask:0xf bank_mask:0xf
    v_dot2c_f32_bf16_dpp v10, v20, v64 row_newbcast:3 row_mask:0xf bank_mask:0xf
    v_dot2c_f32_bf16_dpp v11, v20, v69 row_newbcast:3 row_mask:0xf bank_mask:0xf
    v_dot2c_f32_bf16_dpp v12, v20, v65 row_newbcast:3 row_mask:0xf bank_mask:0xf
    v_dot2c_f32_bf16_dpp v13, v20, v70 row_newbcast:3 row_mask:0xf bank_mask:0xf
    v_dot2c_f32_bf16_dpp v14, v20, v66 row_newbcast:3 row_mask:0xf bank_mask:0xf
    v_dot2c_f32_bf16_dpp v15, v20, v71 row_newbcast:3 row_mask:0xf bank_mask:0xf
    v_dot2c_f32_bf16_dpp v8, v20, v67 row_newbcast:4 row_mask:0xf bank_mask:0xf
    v_dot2c_f32_bf16_dpp v9, v20, v76 row_newbcast:4 row_mask:0xf bank_mask:0xf
    v_dot2c_f32_bf16_dpp v10, v20, v72 row_newbcast:4 row_mask:0xf bank_mask:0xf
    v_dot2c_f32_bf16_dpp v11, v20, v77 row_newbcast:4 row_mask:0xf bank_mask:0xf
    v_dot2c_f32_bf16_dpp v12, v20, v73 row_newbcast:4 row_mask:0xf bank_mask:0xf
    v_dot2c_f32_bf16_dpp v13, v20, v78 row_newbcast:4 row_mask:0xf bank_mask:0xf
    v_dot2c_f32_bf16_dpp v14, v20, v74 row_newbcast:4 row_mask:0xf bank_mask:0xf
    v_dot2c_f32_bf16_dpp v15, v20, v79 row_newbcast:4 row_mask:0xf bank_mask:0xf
    v_dot2c_f32_bf16_dpp v8, v20, v75 row_newbcast:5 row_mask:0xf bank_mask:0xf
    v_dot2c_f32_bf16_dpp v9, v20, v84 row_newbcast:5 row_mask:0xf bank_mask:0xf
    v_dot2c_f32_bf16_dpp v10, v20, v80 row_newbcast:5 row_mask:0xf bank_mask:0xf
    v_dot2c_f32_bf16_dpp v11, v20, v85 row_newbcast:5 row_mask:0xf bank_mask:0xf
    v_dot2c_f32_bf16_dpp v12, v20, v81 row_newbcast:5 row_mask:0xf bank_mask:0xf
    v_dot2c_f32_bf16_dpp v13, v20, v86 row_newbcast:5 row_mask:0xf bank_mask:0xf
    v_dot2c_f32_bf16_dpp v14, v20, v82 row_newbcast:5 row_mask:0xf bank_mask:0xf
    v_dot2c_f32_bf16_dpp v15, v20, v87 row_newbcast:5 row_mask:0xf bank_mask:0xf
    v_dot2c_f32_bf16_dpp v8, v20, v115 row_newbcast:6 row_mask:0xf bank_mask:0xf
    v_dot2c_f32_bf16_dpp v9, v20, v108 row_newbcast:6 row_mask:0xf bank_mask:0xf
    v_dot2c_f32_bf16_dpp v10, v20, v104 row_newbcast:6 row_mask:0xf bank_mask:0xf
    v_dot2c_f32_bf16_dpp v11, v20, v109 row_newbcast:6 row_mask:0xf bank_mask:0xf
    v_dot2c_f32_bf16_dpp v12, v20, v105 row_newbcast:6 row_mask:0xf bank_mask:0xf
    v_dot2c_f32_bf16_dpp v13, v20, v110 row_newbcast:6 row_mask:0xf bank_mask:0xf
    v_dot2c_f32_bf16_dpp v14, v20, v106 row_newbcast:6 row_mask:0xf bank_mask:0xf
    v_dot2c_f32_bf16_dpp v15, v20, v111 row_newbcast:6 row_mask:0xf bank_mask:0xf
    v_dot2c_f32_bf16_dpp v8, v20, v107 row_newbcast:7 row_mask:0xf bank_mask:0xf
    v_dot2c_f32_bf16_dpp v9, v20, v116 row_newbcast:7 row_mask:0xf bank_mask:0xf
    v_dot2c_f32_bf16_dpp v10, v20, v112 row_newbcast:7 row_mask:0xf bank_mask:0xf
    v_dot2c_f32_bf16_dpp v11, v20, v117 row_newbcast:7 row_mask:0xf bank_mask:0xf
    v_dot2c_f32_bf16_dpp v12, v20, v113 row_newbcast:7 row_mask:0xf bank_mask:0xf
    v_dot2c_f32_bf16_dpp v13, v20, v118 row_newbcast:7 row_mask:0xf bank_mask:0xf
    v_dot2c_f32_bf16_dpp v14, v20, v114 row_newbcast:7 row_mask:0xf bank_mask:0xf
    v_dot2c_f32_bf16_dpp v15, v20, v119 row_newbcast:7 row_mask:0xf bank_mask:0xf
    v_dot2c_f32_bf16_dpp v8, v20, v235 row_newbcast:8 row_mask:0xf bank_mask:0xf
    v_dot2c_f32_bf16_dpp v9, v20, v244 row_newbcast:8 row_mask:0xf bank_mask:0xf
    v_dot2c_f32_bf16_dpp v10, v20, v240 row_newbcast:8 row_mask:0xf bank_mask:0xf
    v_dot2c_f32_bf16_dpp v11, v20, v245 row_newbcast:8 row_mask:0xf bank_mask:0xf
    v_dot2c_f32_bf16_dpp v12, v20, v241 row_newbcast:8 row_mask:0xf bank_mask:0xf
    v_dot2c_f32_bf16_dpp v13, v20, v246 row_newbcast:8 row_mask:0xf bank_mask:0xf
    v_dot2c_f32_bf16_dpp v14, v20, v242 row_newbcast:8 row_mask:0xf bank_mask:0xf
    v_dot2c_f32_bf16_dpp v15, v20, v247 row_newbcast:8 row_mask:0xf bank_mask:0xf
    v_dot2c_f32_bf16_dpp v8, v20, v243 row_newbcast:9 row_mask:0xf bank_mask:0xf
    v_dot2c_f32_bf16_dpp v9, v20, v252 row_newbcast:9 row_mask:0xf bank_mask:0xf
    v_dot2c_f32_bf16_dpp v10, v20, v248 row_newbcast:9 row_mask:0xf bank_mask:0xf
    v_dot2c_f32_bf16_dpp v11, v20, v253 row_newbcast:9 row_mask:0xf bank_mask:0xf
    v_dot2c_f32_bf16_dpp v12, v20, v249 row_newbcast:9 row_mask:0xf bank_mask:0xf
    v_dot2c_f32_bf16_dpp v13, v20, v254 row_newbcast:9 row_mask:0xf bank_mask:0xf
    v_dot2c_f32_bf16_dpp v14, v20, v250 row_newbcast:9 row_mask:0xf bank_mask:0xf
    v_dot2c_f32_bf16_dpp v15, v20, v255 row_newbcast:9 row_mask:0xf bank_mask:0xf
    v_permlane32_swap_b32 v8, v12
    v_permlane32_swap_b32 v9, v13
    v_permlane32_swap_b32 v10, v14
    v_permlane32_swap_b32 v11, v15
    v_add_f32 v8, v8, v12
    v_add_f32 v9, v9, v13
    v_add_f32 v10, v10, v14
    v_add_f32 v11, v11, v15
    s_nop 0
    v_permlane16_swap_b32 v8, v10
    v_permlane16_swap_b32 v9, v11
    v_add_f32 v8, v8, v10
    v_add_f32 v9, v9, v11
    ds_write_b64 v4, v[8:9]
    s_waitcnt lgkmcnt(0)
    s_barrier
    ds_read2st64_b32 v[120:121], v174 offset0:0 offset1:1
    ds_read2st64_b32 v[122:123], v174 offset0:2 offset1:3
    ds_read2st64_b32 v[124:125], v174 offset0:4 offset1:5
    ds_read2st64_b32 v[126:127], v174 offset0:6 offset1:7
    ds_read2st64_b32 v[128:129], v174 offset0:8 offset1:9
    ds_read2st64_b32 v[130:131], v174 offset0:10 offset1:11
    ds_read2st64_b32 v[132:133], v174 offset0:12 offset1:13
    ds_read2st64_b32 v[134:135], v174 offset0:14 offset1:15
    s_waitcnt lgkmcnt(6)
    v_pk_add_f32 v[120:121], v[120:121], v[122:123]
    s_waitcnt lgkmcnt(4)
    v_pk_add_f32 v[124:125], v[124:125], v[126:127]
    s_waitcnt lgkmcnt(2)
    v_pk_add_f32 v[128:129], v[128:129], v[130:131]
    s_waitcnt lgkmcnt(0)
    v_pk_add_f32 v[132:133], v[132:133], v[134:135]
    v_pk_add_f32 v[120:121], v[120:121], v[124:125]
    v_pk_add_f32 v[128:129], v[128:129], v[132:133]
    v_pk_add_f32 v[120:121], v[120:121], v[128:129]
    v_cvt_pk_bf16_f32 v121, v120, v121
    v_lshlrev_b32 v120, 16, v121
    v_mul_f32 v20, s52, v120
    v_exp_f32 v20, -v20
    v_and_b32 v121, s50, v121
    v_add_f32 v20, 1.0, v20
    v_rcp_f32 v20, v20
    s_nop 0
    v_mul_f32 v20, v20, v120
    v_cvt_pk_bf16_f32 v20, v20, v20
    v_and_b32 v20, s50, v20
    v_mul_f32 v20, v20, v121
    v_cvt_pk_bf16_f32 v20, v20, v20
    ds_write_b16 v38, v20
    ds_read_b128 v[120:123], v39
    ds_read_b64 v[124:125], v39 offset:16
    s_waitcnt lgkmcnt(1)
    v_dot2_f32_bf16 v8, v120, v251, 0
    v_dot2_f32_bf16 v9, v120, v196, 0
    v_dot2_f32_bf16 v10, v120, v192, 0
    v_dot2_f32_bf16 v11, v120, v197, 0
    v_dot2_f32_bf16 v12, v120, v193, 0
    v_dot2_f32_bf16 v13, v120, v198, 0
    v_dot2_f32_bf16 v14, v120, v194, 0
    v_dot2_f32_bf16 v15, v120, v199, 0
    v_dot2c_f32_bf16 v8, v121, v195
    v_dot2c_f32_bf16 v9, v121, v204
    v_dot2c_f32_bf16 v10, v121, v200
    v_dot2c_f32_bf16 v11, v121, v205
    v_dot2c_f32_bf16 v12, v121, v201
    v_dot2c_f32_bf16 v13, v121, v206
    v_dot2c_f32_bf16 v14, v121, v202
    v_dot2c_f32_bf16 v15, v121, v207
    v_dot2c_f32_bf16 v8, v122, v203
    v_dot2c_f32_bf16 v9, v122, v212
    v_dot2c_f32_bf16 v10, v122, v208
    v_dot2c_f32_bf16 v11, v122, v213
    v_dot2c_f32_bf16 v12, v122, v209
    v_dot2c_f32_bf16 v13, v122, v214
    v_dot2c_f32_bf16 v14, v122, v210
    v_dot2c_f32_bf16 v15, v122, v215
    v_dot2c_f32_bf16 v8, v123, v211
    v_dot2c_f32_bf16 v9, v123, v220
    v_dot2c_f32_bf16 v10, v123, v216
    v_dot2c_f32_bf16 v11, v123, v221
    v_dot2c_f32_bf16 v12, v123, v217
    v_dot2c_f32_bf16 v13, v123, v222
    v_dot2c_f32_bf16 v14, v123, v218
    v_dot2c_f32_bf16 v15, v123, v223
    s_waitcnt lgkmcnt(0)
    v_dot2c_f32_bf16 v8, v124, v219
    v_dot2c_f32_bf16 v9, v124, v228
    v_dot2c_f32_bf16 v10, v124, v224
    v_dot2c_f32_bf16 v11, v124, v229
    v_dot2c_f32_bf16 v12, v124, v225
    v_dot2c_f32_bf16 v13, v124, v230
    v_dot2c_f32_bf16 v14, v124, v226
    v_dot2c_f32_bf16 v15, v124, v231
    v_dot2c_f32_bf16 v8, v125, v227
    v_dot2c_f32_bf16 v9, v125, v236
    v_dot2c_f32_bf16 v10, v125, v232
    v_dot2c_f32_bf16 v11, v125, v237
    v_dot2c_f32_bf16 v12, v125, v233
    v_dot2c_f32_bf16 v13, v125, v238
    v_dot2c_f32_bf16 v14, v125, v234
    v_dot2c_f32_bf16 v15, v125, v239
    ds_write_b128 v28, v[8:11]
    s_nop 1
    ds_write_b128 v28, v[12:15] offset:8320
    s_waitcnt lgkmcnt(0)
    s_barrier
    s_cmp_ge_u32 s40, 3
    s_cbranch_scc1 L_pub2
    v_cmp_gt_u32 vcc, 160, v0
    s_nop 0
    s_mov_b64 exec, vcc
    ds_read_b128 v[120:123], v175 offset:0
    ds_read_b128 v[124:127], v175 offset:1280
    ds_read_b128 v[128:131], v175 offset:2560
    ds_read_b128 v[132:135], v175 offset:3840
    ds_read_b128 v[136:139], v175 offset:5120
    ds_read_b128 v[140:143], v175 offset:6400
    s_waitcnt lgkmcnt(4)
    v_pk_add_f32 v[120:121], v[120:121], v[124:125]
    v_pk_add_f32 v[122:123], v[122:123], v[126:127]
    s_waitcnt lgkmcnt(2)
    v_pk_add_f32 v[128:129], v[128:129], v[132:133]
    v_pk_add_f32 v[130:131], v[130:131], v[134:135]
    v_pk_add_f32 v[120:121], v[120:121], v[128:129]
    v_pk_add_f32 v[122:123], v[122:123], v[130:131]
    s_waitcnt lgkmcnt(0)
    v_pk_add_f32 v[136:137], v[136:137], v[140:141]
    v_pk_add_f32 v[138:139], v[138:139], v[142:143]
    v_pk_add_f32 v[120:121], v[120:121], v[136:137]
    v_pk_add_f32 v[122:123], v[122:123], v[138:139]
    v_min_u32 v120, -2, v120
    v_min_u32 v121, -2, v121
    v_min_u32 v122, -2, v122
    v_min_u32 v123, -2, v123
    buffer_store_dwordx4 v[120:123], v30, s[28:31], s46 offen sc1
    s_mov_b64 exec, -1
    s_branch L_done
L_pub2:
    s_cmp_lg_u32 s40, 7
    s_cbranch_scc1 L_done
    s_cmp_ge_u32 s36, 20
    s_cbranch_scc1 L_done
    s_setprio 3
    s_mul_i32 s46, s41, 81920
    s_lshl_b32 s47, s36, 7
    s_add_u32 s46, s46, s47
    s_add_u32 s46, s46, 0x200000
    s_add_u32 s47, s46, 20480
    s_add_u32 s48, s46, 40960
    s_add_u32 s59, s46, 61440
    s_mov_b32 s55, 0x40000
    s_mul_i32 s60, s41, 1280
L_poll3:
    buffer_load_dwordx4 v[120:123], v177, s[28:31], s46 offen sc1
    buffer_load_dwordx4 v[124:127], v177, s[28:31], s47 offen sc1
    buffer_load_dwordx4 v[128:131], v177, s[28:31], s48 offen sc1
    buffer_load_dwordx4 v[132:135], v178, s[28:31], s59 offen sc1
    s_waitcnt vmcnt(0)
    v_max3_u32 v22, v120, v121, v122
    v_max3_u32 v23, v123, v124, v125
    v_max3_u32 v22, v22, v126, v127
    v_max3_u32 v23, v23, v128, v129
    v_max3_u32 v22, v22, v130, v131
    v_max3_u32 v23, v23, v132, v133
    v_max3_u32 v22, v22, v134, v135
    v_max_u32 v22, v22, v23
    v_cmp_eq_u32 vcc, -1, v22
    s_cbranch_vccz L_poll3_ok
    s_sub_u32 s55, s55, 1
    s_cbranch_scc1 L_poll3_ok
    s_sleep 1
    s_branch L_poll3
L_poll3_ok:
    v_pk_add_f32 v[120:121], v[120:121], v[124:125]
    v_pk_add_f32 v[122:123], v[122:123], v[126:127]
    v_pk_add_f32 v[128:129], v[128:129], v[132:133]
    v_pk_add_f32 v[130:131], v[130:131], v[134:135]
    v_pk_add_f32 v[120:121], v[120:121], v[128:129]
    v_pk_add_f32 v[122:123], v[122:123], v[130:131]
    s_nop 1
    v_permlane32_swap_b32 v120, v122
    v_permlane32_swap_b32 v121, v123
    v_add_f32 v120, v120, v122
    v_add_f32 v121, v121, v123
    s_nop 1
    v_permlane16_swap_b32 v120, v121
    v_add_f32 v120, v120, v121
    s_nop 1
    v_add_f32_dpp v120, v120, v120 row_ror:8 row_mask:0xf bank_mask:0xf
    v_cvt_pk_bf16_f32 v120, v120, v120
    v_and_b32 v120, s50, v120
    v_add_f32 v120, v181, v120
    v_cvt_pk_bf16_f32 v120, v120, v120
    buffer_store_short v120, v179, s[32:35], s60 offen
L_done:
L_end:
    s_endpgm
.section .rodata,"a"
.p2align 6
.amdhsa_kernel sequential_preLN__mha_block_cached__swiglu_ffn__decode_kernel
  .amdhsa_next_free_vgpr 256
  .amdhsa_next_free_sgpr 102
  .amdhsa_accum_offset 256
  .amdhsa_group_segment_fixed_size 0
  .amdhsa_kernarg_size 96
  .amdhsa_user_sgpr_count 2
  .amdhsa_user_sgpr_kernarg_segment_ptr 1
  .amdhsa_system_sgpr_workgroup_id_x 1
.end_amdhsa_kernel
```
